```python
import torch

def _softmax(x, axis=-1):
    return torch.softmax(x, dim=axis)
def _gelu(x):
    return torch.nn.functional.gelu(x, approximate="tanh")
def _silu(x):
    return torch.nn.functional.silu(x)
def _sigmoid(x):
    return torch.sigmoid(x)
def _layernorm(x, axis=-1, eps=1e-5):
    m = x.mean(dim=axis, keepdim=True)
    v = x.var(dim=axis, keepdim=True, unbiased=False)
    return (x - m) / torch.sqrt(v + eps)
def _scatter_add(tgt, idx, src, axis=0):
    return tgt.clone().index_add_(axis, idx, src)
def _segment_sum(src, seg, n):
    out = torch.zeros((n,) + src.shape[1:], dtype=src.dtype)
    return out.index_add_(0, seg, src)
def _pad(x, pw):
    flat = tuple(v for pair in reversed(pw) for v in pair)
    return torch.nn.functional.pad(x, flat)

kernel_name = 'sequential_preLN__sliding_block_cached__dense_activation_relu__decode'

def setup_inputs():

    _w = (lambda a: (lambda t: t.to(torch.bfloat16) if t.is_floating_point() else t)(torch.as_tensor(a)))
    def _A_setup():
        B, Sq, D = 8, 1, 576
        Hq, Hkv, Sk, Dh = 32, 16, 8192, 128
        assert Hq % Hkv == 0, (Hq, Hkv)
        return {
            "x": _w((lambda *s: torch.randn(*s, dtype=torch.bfloat16) * 0.05)(B, Sq, D)),
            "k_cache": _w((lambda *s: torch.randn(*s, dtype=torch.bfloat16) * 3.2)(B, Hkv, Sk, Dh)),
            "v_cache": _w((lambda *s: torch.randn(*s, dtype=torch.bfloat16) * 0.4)(B, Hkv, Sk, Dh)),
            "wq": _w((lambda *s: torch.randn(*s, dtype=torch.bfloat16) * 3.2)(D, Hq * Dh) * (D ** -0.5)),
            "wo": _w((lambda *s: torch.randn(*s, dtype=torch.bfloat16) * 0.4)(Hq * Dh, D) * ((Hq * Dh) ** -0.5)),
        }
    _A_in = _A_setup()

    def _B_setup():
        B, S, D, Dff = 8, 1, 576, 4608
        return {
            "x": _w((lambda *s: torch.randn(*s, dtype=torch.bfloat16) * 0.05)(B, S, D)),
            "w1": _w((lambda *s: torch.randn(*s, dtype=torch.bfloat16) * 0.05)(D, Dff)),
            "w2": _w((lambda *s: torch.randn(*s, dtype=torch.bfloat16) * 0.05)(Dff, D)),
        }
    _B_in = _B_setup()

    return {
        "A_x": _A_in["x"],
        "A_k_cache": _A_in["k_cache"],
        "A_v_cache": _A_in["v_cache"],
        "A_wq": _A_in["wq"],
        "A_wo": _A_in["wo"],
        "B_x": _B_in["x"],
        "B_w1": _B_in["w1"],
        "B_w2": _B_in["w2"],
    }

def reference(A_x, A_k_cache, A_v_cache, A_wq, A_wo, B_x, B_w1, B_w2):
    def _A_ref(x, k_cache, v_cache, wq, wo):
        B, Sq, D = x.shape
        Hq, Dh = 32, 128
        Hkv, Sk = k_cache.shape[1], k_cache.shape[2]
        W = min(4096, max(256, Sk // 4))
        rep = Hq // Hkv
        q = (lambda x, *d: x.permute(*d))((x @ wq).reshape(B, Sq, Hq, Dh), 0, 2, 1, 3)
        k = (lambda x, n, axis: torch.repeat_interleave(x, n, dim=axis))(k_cache[:, :, Sk - W:, :], rep, axis=1)
        v = (lambda x, n, axis: torch.repeat_interleave(x, n, dim=axis))(v_cache[:, :, Sk - W:, :], rep, axis=1)
        scores = torch.einsum("bhqd,bhkd->bhqk", q, k) * (Dh ** -0.5)
        p = _softmax(scores, axis=-1)
        o = torch.einsum("bhqk,bhkd->bhqd", p, v)
        return (lambda x, *d: x.permute(*d))(o, 0, 2, 1, 3).reshape(B, Sq, Hq * Dh) @ wo

    def _B_ref(x, w1, w2):
        h = torch.einsum("bsd,df->bsf", x, w1)
        zero = torch.zeros_like(h)
        h = torch.maximum(h, zero)
        return torch.einsum("bsf,fd->bsd", h, w2)

    x = A_x
    h = x + _A_ref(_layernorm(x, axis=-1), A_k_cache, A_v_cache, A_wq, A_wo)
    h2 = h + _B_ref(_layernorm(h, axis=-1), B_w1, B_w2)
    return h2
```

```asm
; @launch grid=(256,1,1) block=(1024,1,1) lds=159744
.amdgcn_target "amdgcn-amd-amdhsa--gfx950"
.text
.globl sequential_preLN__sliding_block_cached__dense_activation_relu__decode_kernel
.p2align 8
.type sequential_preLN__sliding_block_cached__dense_activation_relu__decode_kernel,@function
sequential_preLN__sliding_block_cached__dense_activation_relu__decode_kernel:
    s_cmp_ge_u32 s2, 256
    s_cbranch_scc1 L_end
    s_load_dwordx16 s[4:19], s[0:1], 0
    s_load_dwordx2 s[24:25], s[0:1], 80
    s_load_dwordx2 s[20:21], s[0:1], 64
    v_lshrrev_b32 v1, 6, v0
    v_and_b32 v0, 63, v0
    v_readfirstlane_b32 s3, v1
    v_mov_b32 v120, 0
    v_mov_b32 v121, 0
    v_mov_b32 v122, 0
    v_mov_b32 v123, 0
    ds_write_b128 v120, v[120:123] offset:26752
    ds_write_b128 v120, v[120:123] offset:26768
    ds_write_b128 v120, v[120:123] offset:26784
    ds_write_b128 v120, v[120:123] offset:26800
    v_and_b32 v1, 15, v0
    v_lshrrev_b32 v2, 4, v0
    v_lshlrev_b32 v3, 6, v1
    v_lshl_add_u32 v3, v2, 4, v3
    v_lshlrev_b32 v4, 4, v0
    s_setprio 3
    s_and_b32 s76, s2, 7
    s_lshr_b32 s77, s2, 3
    s_lshr_b32 s75, s2, 7
    s_lshl_b32 s64, s76, 1
    s_add_u32 s64, s64, s75
    s_lshl_b32 s72, s76, 5
    s_add_u32 s72, s72, s77
    s_bfe_u32 s65, s2, 0x30004
    s_lshl_b32 s68, s65, 4
    s_add_u32 s68, s68, s64
    s_lshl_b32 s68, s68, 21
    s_add_u32 s68, s68, 0x180000
    s_bfe_u32 s75, s2, 0x10003
    s_lshl_b32 s75, s75, 18
    s_add_u32 s68, s68, s75
    s_lshr_b32 s75, s3, 2
    s_lshl_b32 s75, s75, 16
    s_add_u32 s68, s68, s75
    s_and_b32 s75, s3, 3
    s_lshl_b32 s75, s75, 10
    s_add_u32 s68, s68, s75
    s_mov_b32 s69, s68
    s_waitcnt lgkmcnt(0)
    s_load_dword s26, s[24:25], 0
    s_mov_b32 s32, s6
    s_mov_b32 s33, s7
    s_mov_b32 s34, 268435456
    s_mov_b32 s35, 0x00020000
    s_cmp_lt_u32 s3, 8
    s_cbranch_scc1 L_qin
    buffer_load_dwordx4 v[56:59], v3, s[32:35], s68 offen nt
    s_add_u32 s68, s68, 4096
    buffer_load_dwordx4 v[60:63], v3, s[32:35], s68 offen nt
    s_add_u32 s68, s68, 4096
    buffer_load_dwordx4 v[64:67], v3, s[32:35], s68 offen nt
    s_add_u32 s68, s68, 4096
    buffer_load_dwordx4 v[68:71], v3, s[32:35], s68 offen nt
    s_add_u32 s68, s68, 4096
    s_branch L_nox
L_qin:
    s_mov_b32 s28, s4
    s_mov_b32 s29, s5
    s_mov_b32 s30, 9216
    s_mov_b32 s31, 0x00020000
    s_mov_b32 s40, s10
    s_mov_b32 s41, s11
    s_mov_b32 s42, 4718592
    s_mov_b32 s43, 0x00020000
    s_mul_i32 s73, s3, 1152
    v_lshlrev_b32 v5, 3, v0
    v_lshlrev_b32 v6, 1, v0
    buffer_load_dwordx2 v[24:25], v5, s[28:31], s73 offen
    buffer_load_dwordx2 v[26:27], v5, s[28:31], s73 offen offset:512
    buffer_load_ushort v28, v6, s[28:31], s73 offen offset:1024
    s_lshl_b32 s73, s76, 3
    s_and_b32 s66, s77, 7
    s_add_u32 s66, s66, s73
    s_lshr_b32 s67, s2, 6
    s_lshl_b32 s73, s66, 7
    s_mul_i32 s75, s67, 1179648
    s_add_u32 s73, s73, s75
    s_lshl_b32 s75, s3, 16
    s_add_u32 s73, s73, s75
    v_lshrrev_b32 v5, 3, v0
    v_lshlrev_b32 v5, 13, v5
    v_and_b32 v6, 7, v0
    v_lshl_add_u32 v5, v6, 4, v5
    s_lshl_b32 s75, s3, 10
    s_add_u32 m0, s75, 33792
    s_nop 0
    buffer_load_dwordx4 v5, s[40:43], s73 offen nt lds
    s_add_u32 m0, s75, 41984
    s_add_u32 s73, s73, 524288
    buffer_load_dwordx4 v5, s[40:43], s73 offen nt lds
    s_cmp_ge_u32 s3, 2
    s_cbranch_scc1 L_nox
    s_add_u32 m0, s75, 50176
    s_add_u32 s73, s73, 524288
    buffer_load_dwordx4 v5, s[40:43], s73 offen nt lds
L_nox:
    s_barrier
    s_mov_b32 s28, s4
    s_mov_b32 s29, s5
    s_mov_b32 s30, 9216
    s_mov_b32 s31, 0x00020000
    s_mov_b32 s36, s8
    s_mov_b32 s37, s9
    s_mov_b32 s38, 268435456
    s_mov_b32 s39, 0x00020000
    s_mov_b32 s44, s12
    s_mov_b32 s45, s13
    s_mov_b32 s46, 4718592
    s_mov_b32 s47, 0x00020000
    s_mov_b32 s48, s16
    s_mov_b32 s49, s17
    s_mov_b32 s50, 5308416
    s_mov_b32 s51, 0x00020000
    s_mov_b32 s52, s18
    s_mov_b32 s53, s19
    s_mov_b32 s54, 5308416
    s_mov_b32 s55, 0x00020000
    s_mov_b32 s56, s20
    s_mov_b32 s57, s21
    s_mov_b32 s58, 9216
    s_mov_b32 s59, 0x00020000
    s_mov_b32 s60, s24
    s_mov_b32 s61, s25
    s_mov_b32 s62, 1073741824
    s_mov_b32 s63, 0x00020000
    s_mov_b32 s4, s76
    s_mov_b32 s5, s77
    s_mov_b32 s96, 0xffff0000
    s_mov_b32 s97, 0xfffffff8
    s_mov_b32 s98, 0x3fb8aa3b
    s_mov_b32 s74, 200000
    s_mov_b32 s14, 0x00ff00ff
    s_mov_b32 s15, 0x00ff00ff
    s_mov_b32 s16, 0x000f000f
    s_mov_b32 s17, 0x000f000f
    s_cmp_ge_u32 s3, 8
    s_cbranch_scc1 L_stream_hi
    s_waitcnt vmcnt(0)
    v_lshlrev_b32 v8, 16, v24
    v_and_b32 v9, s96, v24
    v_lshlrev_b32 v10, 16, v25
    v_and_b32 v11, s96, v25
    v_lshlrev_b32 v12, 16, v26
    v_and_b32 v13, s96, v26
    v_lshlrev_b32 v14, 16, v27
    v_and_b32 v15, s96, v27
    v_lshlrev_b32 v16, 16, v28
    s_nop 0
    v_readfirstlane_b32 s100, v8
    s_mul_i32 s73, s3, 1168
    s_nop 0
    v_pk_add_f32 v[40:41], v[8:9], s[100:101] op_sel_hi:[1,0] neg_lo:[0,1] neg_hi:[0,1]
    v_pk_add_f32 v[42:43], v[10:11], s[100:101] op_sel_hi:[1,0] neg_lo:[0,1] neg_hi:[0,1]
    v_pk_add_f32 v[44:45], v[12:13], s[100:101] op_sel_hi:[1,0] neg_lo:[0,1] neg_hi:[0,1]
    v_pk_add_f32 v[46:47], v[14:15], s[100:101] op_sel_hi:[1,0] neg_lo:[0,1] neg_hi:[0,1]
    v_subrev_f32 v48, s100, v16
    v_pk_add_f32 v[50:51], v[40:41], v[42:43]
    v_pk_mul_f32 v[52:53], v[40:41], v[40:41]
    v_pk_add_f32 v[54:55], v[44:45], v[46:47]
    v_pk_fma_f32 v[52:53], v[42:43], v[42:43], v[52:53]
    v_pk_add_f32 v[50:51], v[50:51], v[54:55]
    v_pk_fma_f32 v[52:53], v[44:45], v[44:45], v[52:53]
    v_add_f32 v50, v50, v51
    v_pk_fma_f32 v[52:53], v[46:47], v[46:47], v[52:53]
    v_add_f32 v50, v50, v48
    v_add_f32 v52, v52, v53
    v_fmac_f32 v52, v48, v48
    s_mov_b32 s99, s100
    s_nop 0
    v_permlane32_swap_b32 v50, v52
    s_nop 0
    v_add_f32 v54, v50, v52
    v_add_f32 v55, v50, v52
    s_nop 1
    v_permlane16_swap_b32 v54, v55
    s_nop 0
    v_add_f32 v54, v54, v55
    s_nop 1
    v_add_f32_dpp v54, v54, v54 row_ror:8 row_mask:0xf bank_mask:0xf
    s_nop 1
    v_add_f32_dpp v54, v54, v54 row_ror:4 row_mask:0xf bank_mask:0xf
    s_nop 1
    v_add_f32_dpp v54, v54, v54 row_ror:2 row_mask:0xf bank_mask:0xf
    s_nop 1
    v_add_f32_dpp v54, v54, v54 row_ror:1 row_mask:0xf bank_mask:0xf
    v_mov_b32 v55, 0x3ae38e39
    v_readlane_b32 s100, v54, 0
    v_readlane_b32 s101, v54, 32
    s_nop 0
    v_mul_f32 v50, s100, v55
    v_mul_f32 v52, s101, v55
    v_add_f32 v54, s99, v50
    v_fma_f32 v52, -v50, v50, v52
    v_max_f32 v52, 0, v52
    v_cvt_pk_bf16_f32 v55, v54, v52
    v_lshlrev_b32 v54, 16, v55
    v_and_b32 v52, s96, v55
    v_add_f32 v52, 0x3727c5ac, v52
    v_cvt_pk_bf16_f32 v52, v52, v52
    v_and_b32 v52, s96, v52
    v_sqrt_f32 v52, v52
    v_pk_add_f32 v[40:41], v[8:9], v[54:55] op_sel_hi:[1,0] neg_lo:[0,1] neg_hi:[0,1]
    v_pk_add_f32 v[42:43], v[10:11], v[54:55] op_sel_hi:[1,0] neg_lo:[0,1] neg_hi:[0,1]
    v_pk_add_f32 v[44:45], v[12:13], v[54:55] op_sel_hi:[1,0] neg_lo:[0,1] neg_hi:[0,1]
    v_pk_add_f32 v[46:47], v[14:15], v[54:55] op_sel_hi:[1,0] neg_lo:[0,1] neg_hi:[0,1]
    v_sub_f32 v48, v16, v54
    v_cvt_pk_bf16_f32 v52, v52, v52
    v_and_b32 v52, s96, v52
    v_rcp_f32 v52, v52
    v_cvt_pk_bf16_f32 v8, v40, v41
    v_cvt_pk_bf16_f32 v10, v42, v43
    v_cvt_pk_bf16_f32 v12, v44, v45
    v_cvt_pk_bf16_f32 v14, v46, v47
    v_cvt_pk_bf16_f32 v16, v48, v48
    v_lshl_add_u32 v50, v0, 3, s73
    v_lshl_add_u32 v55, v0, 1, s73
    v_lshlrev_b32 v40, 16, v8
    v_and_b32 v41, s96, v8
    v_lshlrev_b32 v42, 16, v10
    v_and_b32 v43, s96, v10
    v_pk_mul_f32 v[40:41], v[40:41], v[52:53] op_sel_hi:[1,0]
    v_pk_mul_f32 v[42:43], v[42:43], v[52:53] op_sel_hi:[1,0]
    v_cvt_pk_bf16_f32 v8, v40, v41
    v_cvt_pk_bf16_f32 v9, v42, v43
    ds_write_b64 v50, v[8:9] offset:0
    v_lshlrev_b32 v44, 16, v12
    v_and_b32 v45, s96, v12
    v_lshlrev_b32 v46, 16, v14
    v_and_b32 v47, s96, v14
    v_pk_mul_f32 v[44:45], v[44:45], v[52:53] op_sel_hi:[1,0]
    v_pk_mul_f32 v[46:47], v[46:47], v[52:53] op_sel_hi:[1,0]
    v_cvt_pk_bf16_f32 v12, v44, v45
    v_cvt_pk_bf16_f32 v13, v46, v47
    ds_write_b64 v50, v[12:13] offset:512
    v_lshlrev_b32 v48, 16, v16
    v_mul_f32 v48, v48, v52
    v_cvt_pk_bf16_f32 v16, v48, v48
    ds_write_b16 v55, v16 offset:1024
    v_mov_b32 v5, 0
    v_mov_b32 v6, 1
    s_mov_b64 exec, 1
    ds_add_u32 v5, v6 offset:26756
    s_mov_b64 exec, -1
    s_cmp_ge_u32 s3, 4
    s_cbranch_scc1 L_stream
    v_lshrrev_b32 v6, 2, v1
    v_lshl_add_u32 v6, v2, 2, v6
    v_lshlrev_b32 v6, 7, v6
    v_and_b32 v7, 3, v1
    v_lshl_add_u32 v6, v7, 3, v6
    s_lshl_b32 s73, s3, 5
    v_add_u32 v6, s73, v6
    v_and_b32 v7, 7, v0
    v_mul_u32_u24 v7, 1168, v7
    v_lshl_add_u32 v7, v2, 3, v7
    s_mul_i32 s73, s67, 288
    v_add_u32 v7, s73, v7
Lspin_1:
    ds_read_b32 v8, v5 offset:26756
    s_waitcnt lgkmcnt(0)
    v_readfirstlane_b32 s101, v8
    s_cmp_ge_u32 s101, 8
    s_cbranch_scc0 Lspin_1
    s_add_u32 s27, s26, 1
    s_lshl_b32 s11, s27, 4
    s_and_b32 s27, s27, 7
    ds_read_b64_tr_b16 v[8:9], v6 offset:33792
    ds_read_b64 v[10:11], v7 offset:0
    ds_read_b64_tr_b16 v[12:13], v6 offset:35840
    ds_read_b64 v[14:15], v7 offset:32
    ds_read_b64_tr_b16 v[16:17], v6 offset:37888
    ds_read_b64 v[18:19], v7 offset:64
    ds_read_b64_tr_b16 v[20:21], v6 offset:39936
    ds_read_b64 v[22:23], v7 offset:96
    ds_read_b64_tr_b16 v[24:25], v6 offset:41984
    ds_read_b64 v[26:27], v7 offset:128
    ds_read_b64_tr_b16 v[28:29], v6 offset:44032
    ds_read_b64 v[30:31], v7 offset:160
    ds_read_b64_tr_b16 v[32:33], v6 offset:46080
    ds_read_b64 v[34:35], v7 offset:192
    ds_read_b64_tr_b16 v[36:37], v6 offset:48128
    ds_read_b64 v[38:39], v7 offset:224
    ds_read_b64_tr_b16 v[40:41], v6 offset:50176
    ds_read_b64 v[42:43], v7 offset:256
    s_cmp_lg_u32 s3, 0
    s_cbranch_scc1 L_noxt
    s_getreg_b32 s12, hwreg(HW_REG_XCC_ID)
    s_and_b32 s12, s12, 15
    s_or_b32 s11, s11, s12
    v_mov_b32 v56, s11
    s_lshl_b32 s73, s72, 2
    s_add_u32 s73, s73, 4096
    s_mov_b64 exec, 1
    buffer_store_dword v56, v5, s[60:63], s73 offen sc1
    s_mov_b64 exec, -1
L_noxt:
    s_waitcnt lgkmcnt(0)
    v_mfma_f32_16x16x16_bf16 v[120:123], v[8:9], v[10:11], 0
    v_mfma_f32_16x16x16_bf16 v[120:123], v[12:13], v[14:15], v[120:123]
    v_mfma_f32_16x16x16_bf16 v[120:123], v[16:17], v[18:19], v[120:123]
    v_mfma_f32_16x16x16_bf16 v[120:123], v[20:21], v[22:23], v[120:123]
    v_mfma_f32_16x16x16_bf16 v[120:123], v[24:25], v[26:27], v[120:123]
    v_mfma_f32_16x16x16_bf16 v[120:123], v[28:29], v[30:31], v[120:123]
    v_mfma_f32_16x16x16_bf16 v[120:123], v[32:33], v[34:35], v[120:123]
    v_mfma_f32_16x16x16_bf16 v[120:123], v[36:37], v[38:39], v[120:123]
    v_mfma_f32_16x16x16_bf16 v[120:123], v[40:41], v[42:43], v[120:123]
    v_lshlrev_b32 v5, 14, v1
    v_lshl_add_u32 v5, v2, 4, v5
    s_lshl_b32 s73, s66, 8
    s_lshl_b32 s75, s67, 17
    s_add_u32 s73, s73, s75
    s_lshl_b32 s75, s3, 6
    s_add_u32 s73, s73, s75
    s_add_u32 s73, s73, 1441792
    v_mov_b32 v7, s27
    s_nop 1
    v_and_or_b32 v8, v120, s97, v7
    v_and_or_b32 v9, v121, s97, v7
    v_and_or_b32 v10, v122, s97, v7
    v_and_or_b32 v11, v123, s97, v7
    s_mov_b64 exec, s[14:15]
    buffer_store_dwordx4 v[8:11], v5, s[60:63], s73 offen sc1 nt
    s_mov_b64 exec, -1
    s_cmp_lg_u32 s3, 0
    s_cbranch_scc1 L_stream
    s_setprio 3
    s_lshl_b32 s73, s65, 14
    s_lshl_b32 s75, s64, 10
    s_add_u32 s73, s73, s75
    s_add_u32 s73, s73, 1441792
    s_add_u32 s75, s73, 131072
    s_add_u32 s76, s73, 262144
    s_add_u32 s77, s73, 393216
    s_lshl_b32 s78, s4, 7
    s_add_u32 s78, s78, 4096
    v_lshlrev_b32 v5, 4, v0
    v_and_b32 v12, 31, v0
    v_lshlrev_b32 v12, 2, v12
    buffer_load_dwordx4 v[56:59], v3, s[32:35], s68 offen nt
    s_add_u32 s68, s68, 4096
    buffer_load_dwordx4 v[60:63], v3, s[32:35], s68 offen nt
    s_add_u32 s68, s68, 4096
    buffer_load_dwordx4 v[64:67], v3, s[32:35], s68 offen nt
    s_add_u32 s68, s68, 4096
    buffer_load_dwordx4 v[68:71], v3, s[32:35], s68 offen nt
    s_add_u32 s68, s68, 4096
    buffer_load_dwordx4 v[72:75], v3, s[32:35], s68 offen nt
    s_add_u32 s68, s68, 4096
    buffer_load_dwordx4 v[76:79], v3, s[32:35], s68 offen nt
    s_add_u32 s68, s68, 4096
    buffer_load_dwordx4 v[80:83], v3, s[32:35], s68 offen nt
    s_add_u32 s68, s68, 4096
    buffer_load_dwordx4 v[84:87], v3, s[32:35], s68 offen nt
    s_add_u32 s68, s68, 4096
    buffer_load_dwordx4 v[88:91], v3, s[32:35], s68 offen nt
    s_add_u32 s68, s68, 4096
    buffer_load_dwordx4 v[92:95], v3, s[32:35], s68 offen nt
    s_add_u32 s68, s68, 4096
    buffer_load_dwordx4 v[96:99], v3, s[32:35], s68 offen nt
    s_add_u32 s68, s68, 4096
    buffer_load_dwordx4 v[100:103], v3, s[32:35], s68 offen nt
    s_add_u32 s68, s68, 4096
    buffer_load_dwordx4 v[104:107], v3, s[32:35], s68 offen nt
    s_add_u32 s68, s68, 4096
    buffer_load_dwordx4 v[108:111], v3, s[32:35], s68 offen nt
    s_add_u32 s68, s68, 4096
    buffer_load_dwordx4 v[112:115], v3, s[32:35], s68 offen nt
    s_add_u32 s68, s68, 4096
    buffer_load_dwordx4 v[116:119], v3, s[32:35], s68 offen nt
    s_add_u32 s68, s68, 4096
L_pollq:
    buffer_load_dwordx4 v[24:27], v5, s[60:63], s73 offen sc1 nt
    buffer_load_dwordx4 v[28:31], v5, s[60:63], s75 offen sc1 nt
    buffer_load_dwordx4 v[32:35], v5, s[60:63], s76 offen sc1 nt
    buffer_load_dwordx4 v[36:39], v5, s[60:63], s77 offen sc1 nt
    buffer_load_dword v13, v12, s[60:63], s78 offen sc1 nt
    s_waitcnt vmcnt(0)
    v_bitop3_b32 v6, v24, v25, s27 bitop3:0x7e
    v_bitop3_b32 v7, v26, v27, s27 bitop3:0x7e
    v_or_b32 v6, v6, v7
    v_bitop3_b32 v7, v28, v29, s27 bitop3:0x7e
    v_or_b32 v6, v6, v7
    v_bitop3_b32 v7, v30, v31, s27 bitop3:0x7e
    v_or_b32 v6, v6, v7
    v_bitop3_b32 v7, v32, v33, s27 bitop3:0x7e
    v_or_b32 v6, v6, v7
    v_bitop3_b32 v7, v34, v35, s27 bitop3:0x7e
    v_or_b32 v6, v6, v7
    v_bitop3_b32 v7, v36, v37, s27 bitop3:0x7e
    v_or_b32 v6, v6, v7
    v_bitop3_b32 v7, v38, v39, s27 bitop3:0x7e
    v_or_b32 v6, v6, v7
    v_xor_b32 v13, s11, v13
    v_cmp_lt_u32 vcc, 15, v13
    s_nop 1
    v_cndmask_b32 v7, 0, 1, vcc
    v_or_b32 v6, v6, v7
    v_and_b32 v6, 7, v6
    v_cmp_ne_u32 vcc, 0, v6
    s_cbranch_vccz Lpd_3
    s_cmp_eq_u32 s74, 0
    s_cbranch_scc1 Lpd_3
    s_sub_u32 s74, s74, 1
    s_sleep 4
    s_branch L_pollq
Lpd_3:
    v_cmp_ne_u32 vcc, 0, v13
    v_and_b32 v24, s97, v24
    v_and_b32 v25, s97, v25
    v_and_b32 v26, s97, v26
    v_and_b32 v27, s97, v27
    v_and_b32 v28, s97, v28
    v_and_b32 v29, s97, v29
    v_and_b32 v30, s97, v30
    v_and_b32 v31, s97, v31
    v_and_b32 v32, s97, v32
    v_and_b32 v33, s97, v33
    v_and_b32 v34, s97, v34
    v_and_b32 v35, s97, v35
    v_and_b32 v36, s97, v36
    v_and_b32 v37, s97, v37
    v_and_b32 v38, s97, v38
    v_and_b32 v39, s97, v39
    s_cmp_eq_u64 vcc, 0
    s_cselect_b32 s73, 2, 1
    v_add_f32 v24, v24, v28
    v_add_f32 v32, v32, v36
    v_add_f32 v25, v25, v29
    v_add_f32 v33, v33, v37
    v_add_f32 v26, v26, v30
    v_add_f32 v34, v34, v38
    v_add_f32 v27, v27, v31
    v_add_f32 v35, v35, v39
    v_add_f32 v24, v24, v32
    v_add_f32 v25, v25, v33
    v_add_f32 v26, v26, v34
    v_add_f32 v27, v27, v35
    v_cvt_pk_bf16_f32 v28, v24, v25
    v_cvt_pk_bf16_f32 v29, v26, v27
    v_lshlrev_b32 v5, 3, v0
    v_mov_b32 v6, 0
    v_mov_b32 v7, s73
    ds_write_b64 v5, v[28:29] offset:26240
    ds_write_b32 v6, v7 offset:26752
    s_sub_u32 s9, s5, 14
    s_lshl_b32 s8, s4, 1
    s_cmp_ge_u32 s9, 9
    s_cselect_b32 s100, 9, 0
    s_addc_u32 s8, s8, 0
    s_sub_u32 s9, s9, s100
    s_branch L_stream_v
L_stream:
    buffer_load_dwordx4 v[56:59], v3, s[32:35], s68 offen nt
    s_add_u32 s68, s68, 4096
    buffer_load_dwordx4 v[60:63], v3, s[32:35], s68 offen nt
    s_add_u32 s68, s68, 4096
    buffer_load_dwordx4 v[64:67], v3, s[32:35], s68 offen nt
    s_add_u32 s68, s68, 4096
    buffer_load_dwordx4 v[68:71], v3, s[32:35], s68 offen nt
    s_add_u32 s68, s68, 4096
L_stream_hi:
    s_sub_u32 s9, s5, 14
    s_lshl_b32 s8, s4, 1
    s_cmp_ge_u32 s9, 9
    s_cselect_b32 s100, 9, 0
    s_addc_u32 s8, s8, 0
    s_sub_u32 s9, s9, s100
    buffer_load_dwordx4 v[72:75], v3, s[32:35], s68 offen nt
    s_add_u32 s68, s68, 4096
    buffer_load_dwordx4 v[76:79], v3, s[32:35], s68 offen nt
    s_add_u32 s68, s68, 4096
    buffer_load_dwordx4 v[80:83], v3, s[32:35], s68 offen nt
    s_add_u32 s68, s68, 4096
    buffer_load_dwordx4 v[84:87], v3, s[32:35], s68 offen nt
    s_add_u32 s68, s68, 4096
    buffer_load_dwordx4 v[88:91], v3, s[32:35], s68 offen nt
    s_add_u32 s68, s68, 4096
    buffer_load_dwordx4 v[92:95], v3, s[32:35], s68 offen nt
    s_add_u32 s68, s68, 4096
    buffer_load_dwordx4 v[96:99], v3, s[32:35], s68 offen nt
    s_add_u32 s68, s68, 4096
    buffer_load_dwordx4 v[100:103], v3, s[32:35], s68 offen nt
    s_add_u32 s68, s68, 4096
    buffer_load_dwordx4 v[104:107], v3, s[32:35], s68 offen nt
    s_add_u32 s68, s68, 4096
    buffer_load_dwordx4 v[108:111], v3, s[32:35], s68 offen nt
    s_add_u32 s68, s68, 4096
    buffer_load_dwordx4 v[112:115], v3, s[32:35], s68 offen nt
    s_add_u32 s68, s68, 4096
    buffer_load_dwordx4 v[116:119], v3, s[32:35], s68 offen nt
    s_add_u32 s68, s68, 4096
L_stream_v:
    s_setprio 0
    v_mov_b32 v5, 0
L_waitq:
    ds_read_b32 v6, v5 offset:26752
    s_waitcnt lgkmcnt(0)
    v_readfirstlane_b32 s6, v6
    s_cmp_lg_u32 s6, 0
    s_cbranch_scc1 L_qready
    s_sleep 4
    s_branch L_waitq
L_qready:
    s_sub_u32 s6, s6, 1
    s_add_u32 s27, s26, 1
    s_and_b32 s27, s27, 0xfff
    s_mov_b32 s97, 0xfffff000
    v_lshrrev_b32 v5, 3, v1
    v_lshlrev_b32 v5, 8, v5
    v_lshl_add_u32 v5, v2, 4, v5
    v_and_b32 v6, 3, v1
    v_lshl_add_u32 v5, v6, 6, v5
    ds_read_b128 v[24:27], v5 offset:26240
    s_waitcnt lgkmcnt(0)
    s_waitcnt vmcnt(12)
    v_mfma_f32_16x16x32_bf16 v[56:59], v[56:59], v[24:27], 0
    v_mfma_f32_16x16x32_bf16 v[60:63], v[60:63], v[24:27], 0
    v_mfma_f32_16x16x32_bf16 v[64:67], v[64:67], v[24:27], 0
    v_mfma_f32_16x16x32_bf16 v[68:71], v[68:71], v[24:27], 0
    s_nop 4
    v_mov_b32_dpp v8, v56 quad_perm:[0,0,0,0] row_mask:0xf bank_mask:0xf
    v_mov_b32_dpp v9, v60 quad_perm:[0,0,0,0] row_mask:0xf bank_mask:0xf
    v_mov_b32_dpp v10, v64 quad_perm:[0,0,0,0] row_mask:0xf bank_mask:0xf
    v_mov_b32_dpp v11, v68 quad_perm:[0,0,0,0] row_mask:0xf bank_mask:0xf
    v_add_f32_dpp v8, v57, v8 quad_perm:[1,1,1,1] row_mask:0xf bank_mask:0xf
    v_add_f32_dpp v9, v61, v9 quad_perm:[1,1,1,1] row_mask:0xf bank_mask:0xf
    v_add_f32_dpp v10, v65, v10 quad_perm:[1,1,1,1] row_mask:0xf bank_mask:0xf
    v_add_f32_dpp v11, v69, v11 quad_perm:[1,1,1,1] row_mask:0xf bank_mask:0xf
    v_add_f32_dpp v8, v58, v8 quad_perm:[2,2,2,2] row_mask:0xf bank_mask:0xf
    v_add_f32_dpp v9, v62, v9 quad_perm:[2,2,2,2] row_mask:0xf bank_mask:0xf
    v_add_f32_dpp v10, v66, v10 quad_perm:[2,2,2,2] row_mask:0xf bank_mask:0xf
    v_add_f32_dpp v11, v70, v11 quad_perm:[2,2,2,2] row_mask:0xf bank_mask:0xf
    v_add_f32_dpp v8, v59, v8 quad_perm:[3,3,3,3] row_mask:0xf bank_mask:0xf
    v_add_f32_dpp v9, v63, v9 quad_perm:[3,3,3,3] row_mask:0xf bank_mask:0xf
    v_add_f32_dpp v10, v67, v10 quad_perm:[3,3,3,3] row_mask:0xf bank_mask:0xf
    v_add_f32_dpp v11, v71, v11 quad_perm:[3,3,3,3] row_mask:0xf bank_mask:0xf
    s_waitcnt vmcnt(8)
    v_mfma_f32_16x16x32_bf16 v[72:75], v[72:75], v[24:27], 0
    v_mfma_f32_16x16x32_bf16 v[76:79], v[76:79], v[24:27], 0
    v_mfma_f32_16x16x32_bf16 v[80:83], v[80:83], v[24:27], 0
    v_mfma_f32_16x16x32_bf16 v[84:87], v[84:87], v[24:27], 0
    s_nop 4
    v_mov_b32_dpp v12, v72 quad_perm:[0,0,0,0] row_mask:0xf bank_mask:0xf
    v_mov_b32_dpp v13, v76 quad_perm:[0,0,0,0] row_mask:0xf bank_mask:0xf
    v_mov_b32_dpp v14, v80 quad_perm:[0,0,0,0] row_mask:0xf bank_mask:0xf
    v_mov_b32_dpp v15, v84 quad_perm:[0,0,0,0] row_mask:0xf bank_mask:0xf
    v_add_f32_dpp v12, v73, v12 quad_perm:[1,1,1,1] row_mask:0xf bank_mask:0xf
    v_add_f32_dpp v13, v77, v13 quad_perm:[1,1,1,1] row_mask:0xf bank_mask:0xf
    v_add_f32_dpp v14, v81, v14 quad_perm:[1,1,1,1] row_mask:0xf bank_mask:0xf
    v_add_f32_dpp v15, v85, v15 quad_perm:[1,1,1,1] row_mask:0xf bank_mask:0xf
    v_add_f32_dpp v12, v74, v12 quad_perm:[2,2,2,2] row_mask:0xf bank_mask:0xf
    v_add_f32_dpp v13, v78, v13 quad_perm:[2,2,2,2] row_mask:0xf bank_mask:0xf
    v_add_f32_dpp v14, v82, v14 quad_perm:[2,2,2,2] row_mask:0xf bank_mask:0xf
    v_add_f32_dpp v15, v86, v15 quad_perm:[2,2,2,2] row_mask:0xf bank_mask:0xf
    v_add_f32_dpp v12, v75, v12 quad_perm:[3,3,3,3] row_mask:0xf bank_mask:0xf
    v_add_f32_dpp v13, v79, v13 quad_perm:[3,3,3,3] row_mask:0xf bank_mask:0xf
    v_add_f32_dpp v14, v83, v14 quad_perm:[3,3,3,3] row_mask:0xf bank_mask:0xf
    v_add_f32_dpp v15, v87, v15 quad_perm:[3,3,3,3] row_mask:0xf bank_mask:0xf
    s_waitcnt vmcnt(4)
    v_mfma_f32_16x16x32_bf16 v[88:91], v[88:91], v[24:27], 0
    v_mfma_f32_16x16x32_bf16 v[92:95], v[92:95], v[24:27], 0
    v_mfma_f32_16x16x32_bf16 v[96:99], v[96:99], v[24:27], 0
    v_mfma_f32_16x16x32_bf16 v[100:103], v[100:103], v[24:27], 0
    s_nop 4
    v_mov_b32_dpp v16, v88 quad_perm:[0,0,0,0] row_mask:0xf bank_mask:0xf
    v_mov_b32_dpp v17, v92 quad_perm:[0,0,0,0] row_mask:0xf bank_mask:0xf
    v_mov_b32_dpp v18, v96 quad_perm:[0,0,0,0] row_mask:0xf bank_mask:0xf
    v_mov_b32_dpp v19, v100 quad_perm:[0,0,0,0] row_mask:0xf bank_mask:0xf
    v_add_f32_dpp v16, v89, v16 quad_perm:[1,1,1,1] row_mask:0xf bank_mask:0xf
    v_add_f32_dpp v17, v93, v17 quad_perm:[1,1,1,1] row_mask:0xf bank_mask:0xf
    v_add_f32_dpp v18, v97, v18 quad_perm:[1,1,1,1] row_mask:0xf bank_mask:0xf
    v_add_f32_dpp v19, v101, v19 quad_perm:[1,1,1,1] row_mask:0xf bank_mask:0xf
    v_add_f32_dpp v16, v90, v16 quad_perm:[2,2,2,2] row_mask:0xf bank_mask:0xf
    v_add_f32_dpp v17, v94, v17 quad_perm:[2,2,2,2] row_mask:0xf bank_mask:0xf
    v_add_f32_dpp v18, v98, v18 quad_perm:[2,2,2,2] row_mask:0xf bank_mask:0xf
    v_add_f32_dpp v19, v102, v19 quad_perm:[2,2,2,2] row_mask:0xf bank_mask:0xf
    v_add_f32_dpp v16, v91, v16 quad_perm:[3,3,3,3] row_mask:0xf bank_mask:0xf
    v_add_f32_dpp v17, v95, v17 quad_perm:[3,3,3,3] row_mask:0xf bank_mask:0xf
    v_add_f32_dpp v18, v99, v18 quad_perm:[3,3,3,3] row_mask:0xf bank_mask:0xf
    v_add_f32_dpp v19, v103, v19 quad_perm:[3,3,3,3] row_mask:0xf bank_mask:0xf
    s_waitcnt vmcnt(0)
    v_mfma_f32_16x16x32_bf16 v[104:107], v[104:107], v[24:27], 0
    v_mfma_f32_16x16x32_bf16 v[108:111], v[108:111], v[24:27], 0
    v_mfma_f32_16x16x32_bf16 v[112:115], v[112:115], v[24:27], 0
    v_mfma_f32_16x16x32_bf16 v[116:119], v[116:119], v[24:27], 0
    s_nop 4
    v_mov_b32_dpp v20, v104 quad_perm:[0,0,0,0] row_mask:0xf bank_mask:0xf
    v_mov_b32_dpp v21, v108 quad_perm:[0,0,0,0] row_mask:0xf bank_mask:0xf
    v_mov_b32_dpp v22, v112 quad_perm:[0,0,0,0] row_mask:0xf bank_mask:0xf
    v_mov_b32_dpp v23, v116 quad_perm:[0,0,0,0] row_mask:0xf bank_mask:0xf
    v_add_f32_dpp v20, v105, v20 quad_perm:[1,1,1,1] row_mask:0xf bank_mask:0xf
    v_add_f32_dpp v21, v109, v21 quad_perm:[1,1,1,1] row_mask:0xf bank_mask:0xf
    v_add_f32_dpp v22, v113, v22 quad_perm:[1,1,1,1] row_mask:0xf bank_mask:0xf
    v_add_f32_dpp v23, v117, v23 quad_perm:[1,1,1,1] row_mask:0xf bank_mask:0xf
    v_add_f32_dpp v20, v106, v20 quad_perm:[2,2,2,2] row_mask:0xf bank_mask:0xf
    v_add_f32_dpp v21, v110, v21 quad_perm:[2,2,2,2] row_mask:0xf bank_mask:0xf
    v_add_f32_dpp v22, v114, v22 quad_perm:[2,2,2,2] row_mask:0xf bank_mask:0xf
    v_add_f32_dpp v23, v118, v23 quad_perm:[2,2,2,2] row_mask:0xf bank_mask:0xf
    v_add_f32_dpp v20, v107, v20 quad_perm:[3,3,3,3] row_mask:0xf bank_mask:0xf
    v_add_f32_dpp v21, v111, v21 quad_perm:[3,3,3,3] row_mask:0xf bank_mask:0xf
    v_add_f32_dpp v22, v115, v22 quad_perm:[3,3,3,3] row_mask:0xf bank_mask:0xf
    v_add_f32_dpp v23, v119, v23 quad_perm:[3,3,3,3] row_mask:0xf bank_mask:0xf
    v_and_b32 v5, 7, v1
    v_lshrrev_b32 v6, 1, v5
    v_and_b32 v5, 1, v5
    v_lshlrev_b32 v5, 4, v5
    v_mov_b32 v7, 0xffff
    v_lshlrev_b32 v7, v5, v7
    v_cmp_eq_u32 vcc, 0, v6
    s_nop 1
    v_cndmask_b32 v104, 0, v7, vcc
    v_cmp_eq_u32 vcc, 1, v6
    s_nop 1
    v_cndmask_b32 v105, 0, v7, vcc
    v_cmp_eq_u32 vcc, 2, v6
    s_nop 1
    v_cndmask_b32 v106, 0, v7, vcc
    v_cmp_eq_u32 vcc, 3, v6
    s_nop 1
    v_cndmask_b32 v107, 0, v7, vcc
    v_max3_f32 v108, v8, v9, v10
    v_max3_f32 v108, v108, v11, v12
    v_max3_f32 v108, v108, v13, v14
    v_max3_f32 v108, v108, v15, v16
    v_max3_f32 v108, v108, v17, v18
    v_max3_f32 v108, v108, v19, v20
    v_max3_f32 v108, v108, v21, v22
    v_max_f32 v108, v108, v23
    v_mov_b32 v111, v108
    s_nop 1
    v_permlane32_swap_b32 v108, v111
    s_nop 0
    v_max_f32 v108, v108, v111
    v_mov_b32 v111, v108
    s_nop 1
    v_permlane16_swap_b32 v108, v111
    s_nop 0
    v_max_f32 v108, v108, v111
    v_cvt_pk_bf16_f32 v108, v108, v108
    v_and_b32 v108, s96, v108
    v_mul_f32 v108, 0x3db504f3, v108
    v_cvt_pk_bf16_f32 v108, v108, v108
    v_and_b32 v108, s96, v108
    v_mul_f32 v110, s98, v108
    v_mov_b32 v109, 0
    s_mov_b32 s73, 0x3db504f3
    v_cvt_pk_bf16_f32 v111, v8, v9
    v_lshlrev_b32 v8, 16, v111
    v_and_b32 v9, s96, v111
    v_mul_f32 v8, s73, v8
    v_mul_f32 v9, s73, v9
    v_cvt_pk_bf16_f32 v111, v8, v9
    v_lshlrev_b32 v8, 16, v111
    v_and_b32 v9, s96, v111
    v_fma_f32 v8, v8, s98, -v110
    v_fma_f32 v9, v9, s98, -v110
    v_exp_f32 v8, v8
    v_exp_f32 v9, v9
    s_nop 0
    v_add_f32 v109, v109, v8
    v_cvt_pk_bf16_f32 v8, v8, v8
    v_add_f32 v109, v109, v9
    v_cvt_pk_bf16_f32 v9, v9, v9
    v_cvt_pk_bf16_f32 v111, v10, v11
    v_lshlrev_b32 v10, 16, v111
    v_and_b32 v11, s96, v111
    v_mul_f32 v10, s73, v10
    v_mul_f32 v11, s73, v11
    v_cvt_pk_bf16_f32 v111, v10, v11
    v_lshlrev_b32 v10, 16, v111
    v_and_b32 v11, s96, v111
    v_fma_f32 v10, v10, s98, -v110
    v_fma_f32 v11, v11, s98, -v110
    v_exp_f32 v10, v10
    v_exp_f32 v11, v11
    s_nop 0
    v_add_f32 v109, v109, v10
    v_cvt_pk_bf16_f32 v10, v10, v10
    v_add_f32 v109, v109, v11
    v_cvt_pk_bf16_f32 v11, v11, v11
    v_cvt_pk_bf16_f32 v111, v12, v13
    v_lshlrev_b32 v12, 16, v111
    v_and_b32 v13, s96, v111
    v_mul_f32 v12, s73, v12
    v_mul_f32 v13, s73, v13
    v_cvt_pk_bf16_f32 v111, v12, v13
    v_lshlrev_b32 v12, 16, v111
    v_and_b32 v13, s96, v111
    v_fma_f32 v12, v12, s98, -v110
    v_fma_f32 v13, v13, s98, -v110
    v_exp_f32 v12, v12
    v_exp_f32 v13, v13
    s_nop 0
    v_add_f32 v109, v109, v12
    v_cvt_pk_bf16_f32 v12, v12, v12
    v_add_f32 v109, v109, v13
    v_cvt_pk_bf16_f32 v13, v13, v13
    v_cvt_pk_bf16_f32 v111, v14, v15
    v_lshlrev_b32 v14, 16, v111
    v_and_b32 v15, s96, v111
    v_mul_f32 v14, s73, v14
    v_mul_f32 v15, s73, v15
    v_cvt_pk_bf16_f32 v111, v14, v15
    v_lshlrev_b32 v14, 16, v111
    v_and_b32 v15, s96, v111
    v_fma_f32 v14, v14, s98, -v110
    v_fma_f32 v15, v15, s98, -v110
    v_exp_f32 v14, v14
    v_exp_f32 v15, v15
    s_nop 0
    v_add_f32 v109, v109, v14
    v_cvt_pk_bf16_f32 v14, v14, v14
    v_add_f32 v109, v109, v15
    v_cvt_pk_bf16_f32 v15, v15, v15
    v_cvt_pk_bf16_f32 v111, v16, v17
    v_lshlrev_b32 v16, 16, v111
    v_and_b32 v17, s96, v111
    v_mul_f32 v16, s73, v16
    v_mul_f32 v17, s73, v17
    v_cvt_pk_bf16_f32 v111, v16, v17
    v_lshlrev_b32 v16, 16, v111
    v_and_b32 v17, s96, v111
    v_fma_f32 v16, v16, s98, -v110
    v_fma_f32 v17, v17, s98, -v110
    v_exp_f32 v16, v16
    v_exp_f32 v17, v17
    s_nop 0
    v_add_f32 v109, v109, v16
    v_cvt_pk_bf16_f32 v16, v16, v16
    v_add_f32 v109, v109, v17
    v_cvt_pk_bf16_f32 v17, v17, v17
    v_cvt_pk_bf16_f32 v111, v18, v19
    v_lshlrev_b32 v18, 16, v111
    v_and_b32 v19, s96, v111
    v_mul_f32 v18, s73, v18
    v_mul_f32 v19, s73, v19
    v_cvt_pk_bf16_f32 v111, v18, v19
    v_lshlrev_b32 v18, 16, v111
    v_and_b32 v19, s96, v111
    v_fma_f32 v18, v18, s98, -v110
    v_fma_f32 v19, v19, s98, -v110
    v_exp_f32 v18, v18
    v_exp_f32 v19, v19
    s_nop 0
    v_add_f32 v109, v109, v18
    v_cvt_pk_bf16_f32 v18, v18, v18
    v_add_f32 v109, v109, v19
    v_cvt_pk_bf16_f32 v19, v19, v19
    v_cvt_pk_bf16_f32 v111, v20, v21
    v_lshlrev_b32 v20, 16, v111
    v_and_b32 v21, s96, v111
    v_mul_f32 v20, s73, v20
    v_mul_f32 v21, s73, v21
    v_cvt_pk_bf16_f32 v111, v20, v21
    v_lshlrev_b32 v20, 16, v111
    v_and_b32 v21, s96, v111
    v_fma_f32 v20, v20, s98, -v110
    v_fma_f32 v21, v21, s98, -v110
    v_exp_f32 v20, v20
    v_exp_f32 v21, v21
    s_nop 0
    v_add_f32 v109, v109, v20
    v_cvt_pk_bf16_f32 v20, v20, v20
    v_add_f32 v109, v109, v21
    v_cvt_pk_bf16_f32 v21, v21, v21
    v_cvt_pk_bf16_f32 v111, v22, v23
    v_lshlrev_b32 v22, 16, v111
    v_and_b32 v23, s96, v111
    v_mul_f32 v22, s73, v22
    v_mul_f32 v23, s73, v23
    v_cvt_pk_bf16_f32 v111, v22, v23
    v_lshlrev_b32 v22, 16, v111
    v_and_b32 v23, s96, v111
    v_fma_f32 v22, v22, s98, -v110
    v_fma_f32 v23, v23, s98, -v110
    v_exp_f32 v22, v22
    v_exp_f32 v23, v23
    s_nop 0
    v_add_f32 v109, v109, v22
    v_cvt_pk_bf16_f32 v22, v22, v22
    v_add_f32 v109, v109, v23
    v_cvt_pk_bf16_f32 v23, v23, v23
    v_mov_b32 v111, v109
    s_nop 1
    v_permlane32_swap_b32 v109, v111
    s_nop 0
    v_add_f32 v109, v109, v111
    v_mov_b32 v111, v109
    s_nop 1
    v_permlane16_swap_b32 v109, v111
    s_nop 0
    v_add_f32 v109, v109, v111
    s_lshl_b32 s73, s3, 4
    v_add_u32 v111, s73, v0
    v_mov_b32 v112, 0
    v_mov_b32 v113, 1
    s_mov_b64 exec, 0x101
    ds_write_b64 v111, v[108:109] offset:25728
    s_mov_b64 exec, 1
    ds_add_u32 v112, v113 offset:26760
    s_mov_b64 exec, -1
    s_lshl_b32 s73, s3, 10
    v_lshl_add_u32 v111, v0, 4, s73
    v_lshrrev_b32 v114, 2, v0
    v_and_b32 v6, 3, v0
    s_lshl_b32 s73, s3, 6
    v_lshl_add_u32 v115, v6, 4, s73
    v_lshl_add_u32 v115, v114, 10, v115
    s_lshr_b32 s75, s3, 3
    s_lshl_b32 s75, s75, 6
    v_lshl_add_u32 v114, v114, 2, s75
    v_and_b32 v127, 1, v2
    v_lshlrev_b32 v127, 3, v127
    v_lshrrev_b32 v7, 1, v2
    v_lshl_add_u32 v127, v7, 2, v127
    v_lshl_add_u32 v117, v6, 4, v127
    s_lshl_b32 s76, s72, 10
    s_add_u32 s76, s76, s73
    s_add_u32 s76, s76, 262144
    v_mov_b32 v116, s27
    v_mov_b32 v118, 1
    v_lshrrev_b32 v124, 2, v1
    v_lshl_add_u32 v124, v2, 3, v124
    v_and_b32 v125, 3, v1
    v_lshlrev_b32 v125, 3, v125
    v_and_b32 v126, 7, v0
    buffer_load_dwordx4 v[28:31], v4, s[36:39], s69 offen nt
    s_add_u32 s69, s69, 4096
    buffer_load_dwordx4 v[32:35], v4, s[36:39], s69 offen nt
    s_add_u32 s69, s69, 4096
    buffer_load_dwordx4 v[36:39], v4, s[36:39], s69 offen nt
    s_add_u32 s69, s69, 4096
    buffer_load_dwordx4 v[40:43], v4, s[36:39], s69 offen nt
    s_add_u32 s69, s69, 4096
    buffer_load_dwordx4 v[44:47], v4, s[36:39], s69 offen nt
    s_add_u32 s69, s69, 4096
    buffer_load_dwordx4 v[48:51], v4, s[36:39], s69 offen nt
    s_add_u32 s69, s69, 4096
    buffer_load_dwordx4 v[52:55], v4, s[36:39], s69 offen nt
    s_add_u32 s69, s69, 4096
    buffer_load_dwordx4 v[56:59], v4, s[36:39], s69 offen nt
    s_add_u32 s69, s69, 4096
    buffer_load_dwordx4 v[60:63], v4, s[36:39], s69 offen nt
    s_add_u32 s69, s69, 4096
    buffer_load_dwordx4 v[64:67], v4, s[36:39], s69 offen nt
    s_add_u32 s69, s69, 4096
    buffer_load_dwordx4 v[68:71], v4, s[36:39], s69 offen nt
    s_add_u32 s69, s69, 4096
    buffer_load_dwordx4 v[72:75], v4, s[36:39], s69 offen nt
    s_add_u32 s69, s69, 4096
    buffer_load_dwordx4 v[76:79], v4, s[36:39], s69 offen nt
    s_add_u32 s69, s69, 4096
    buffer_load_dwordx4 v[80:83], v4, s[36:39], s69 offen nt
    s_add_u32 s69, s69, 4096
    buffer_load_dwordx4 v[84:87], v4, s[36:39], s69 offen nt
    s_add_u32 s69, s69, 4096
    buffer_load_dwordx4 v[88:91], v4, s[36:39], s69 offen nt
    s_add_u32 s69, s69, 4096
    s_mov_b64 exec, 1
    ds_add_u32 v112, v118 offset:26800
    s_mov_b64 exec, -1
    v_and_b32 v92, v8, v104
    v_and_b32 v93, v8, v105
    v_and_b32 v94, v8, v106
    v_and_b32 v95, v8, v107
    s_waitcnt vmcnt(15)
    s_nop 0
    v_mfma_f32_16x16x32_bf16 v[120:123], v[92:95], v[28:31], 0
    v_and_b32 v96, v9, v104
    v_and_b32 v97, v9, v105
    v_and_b32 v98, v9, v106
    v_and_b32 v99, v9, v107
    s_waitcnt vmcnt(14)
    s_nop 0
    v_mfma_f32_16x16x32_bf16 v[120:123], v[96:99], v[32:35], v[120:123]
    v_and_b32 v100, v10, v104
    v_and_b32 v101, v10, v105
    v_and_b32 v102, v10, v106
    v_and_b32 v103, v10, v107
    s_waitcnt vmcnt(13)
    s_nop 0
    v_mfma_f32_16x16x32_bf16 v[120:123], v[100:103], v[36:39], v[120:123]
    v_and_b32 v92, v11, v104
    v_and_b32 v93, v11, v105
    v_and_b32 v94, v11, v106
    v_and_b32 v95, v11, v107
    s_waitcnt vmcnt(12)
    s_nop 0
    v_mfma_f32_16x16x32_bf16 v[120:123], v[92:95], v[40:43], v[120:123]
    v_and_b32 v96, v12, v104
    v_and_b32 v97, v12, v105
    v_and_b32 v98, v12, v106
    v_and_b32 v99, v12, v107
    s_waitcnt vmcnt(11)
    s_nop 0
    v_mfma_f32_16x16x32_bf16 v[120:123], v[96:99], v[44:47], v[120:123]
    v_and_b32 v100, v13, v104
    v_and_b32 v101, v13, v105
    v_and_b32 v102, v13, v106
    v_and_b32 v103, v13, v107
    s_waitcnt vmcnt(10)
    s_nop 0
    v_mfma_f32_16x16x32_bf16 v[120:123], v[100:103], v[48:51], v[120:123]
    v_and_b32 v92, v14, v104
    v_and_b32 v93, v14, v105
    v_and_b32 v94, v14, v106
    v_and_b32 v95, v14, v107
    s_waitcnt vmcnt(9)
    s_nop 0
    v_mfma_f32_16x16x32_bf16 v[120:123], v[92:95], v[52:55], v[120:123]
    v_and_b32 v96, v15, v104
    v_and_b32 v97, v15, v105
    v_and_b32 v98, v15, v106
    v_and_b32 v99, v15, v107
    s_waitcnt vmcnt(8)
    s_nop 0
    v_mfma_f32_16x16x32_bf16 v[120:123], v[96:99], v[56:59], v[120:123]
    v_and_b32 v100, v16, v104
    v_and_b32 v101, v16, v105
    v_and_b32 v102, v16, v106
    v_and_b32 v103, v16, v107
    s_waitcnt vmcnt(7)
    s_nop 0
    v_mfma_f32_16x16x32_bf16 v[120:123], v[100:103], v[60:63], v[120:123]
    v_and_b32 v92, v17, v104
    v_and_b32 v93, v17, v105
    v_and_b32 v94, v17, v106
    v_and_b32 v95, v17, v107
    s_waitcnt vmcnt(6)
    s_nop 0
    v_mfma_f32_16x16x32_bf16 v[120:123], v[92:95], v[64:67], v[120:123]
    v_and_b32 v96, v18, v104
    v_and_b32 v97, v18, v105
    v_and_b32 v98, v18, v106
    v_and_b32 v99, v18, v107
    s_waitcnt vmcnt(5)
    s_nop 0
    v_mfma_f32_16x16x32_bf16 v[120:123], v[96:99], v[68:71], v[120:123]
    v_and_b32 v100, v19, v104
    v_and_b32 v101, v19, v105
    v_and_b32 v102, v19, v106
    v_and_b32 v103, v19, v107
    s_waitcnt vmcnt(4)
    s_nop 0
    v_mfma_f32_16x16x32_bf16 v[120:123], v[100:103], v[72:75], v[120:123]
    v_and_b32 v92, v20, v104
    v_and_b32 v93, v20, v105
    v_and_b32 v94, v20, v106
    v_and_b32 v95, v20, v107
    s_waitcnt vmcnt(3)
    s_nop 0
    v_mfma_f32_16x16x32_bf16 v[120:123], v[92:95], v[76:79], v[120:123]
    v_and_b32 v96, v21, v104
    v_and_b32 v97, v21, v105
    v_and_b32 v98, v21, v106
    v_and_b32 v99, v21, v107
    s_waitcnt vmcnt(2)
    s_nop 0
    v_mfma_f32_16x16x32_bf16 v[120:123], v[96:99], v[80:83], v[120:123]
    v_and_b32 v100, v22, v104
    v_and_b32 v101, v22, v105
    v_and_b32 v102, v22, v106
    v_and_b32 v103, v22, v107
    s_waitcnt vmcnt(1)
    s_nop 0
    v_mfma_f32_16x16x32_bf16 v[120:123], v[100:103], v[84:87], v[120:123]
    v_and_b32 v92, v23, v104
    v_and_b32 v93, v23, v105
    v_and_b32 v94, v23, v106
    v_and_b32 v95, v23, v107
    s_waitcnt vmcnt(0)
    s_nop 0
    v_mfma_f32_16x16x32_bf16 v[120:123], v[92:95], v[88:91], v[120:123]
    s_cmp_ge_u32 s3, 12
    s_nop 6
    ds_write_b128 v111, v[120:123] offset:9344
    s_cbranch_scc1 L_noml
    s_cmp_ge_u32 s3, 8
    s_cbranch_scc1 L_hipre
    s_cmp_lt_u32 s5, 14
    s_cbranch_scc1 Ltd_4
Lspin_6:
    ds_read_b32 v113, v112 offset:26800
    s_waitcnt lgkmcnt(0)
    v_readfirstlane_b32 s101, v113
    s_cmp_ge_u32 s101, 16
    s_cbranch_scc1 Lspind_7
    s_sleep 2
    s_branch Lspin_6
Lspind_7:
    s_lshl_b32 s12, s3, 2
    s_mul_i32 s75, s8, 294912
    s_lshl_b32 s73, s9, 7
    s_add_u32 s73, s73, s75
    s_mul_i32 s75, s12, 9216
    s_add_u32 s73, s73, s75
    v_lshrrev_b32 v5, 3, v0
    v_mul_u32_u24 v5, 1152, v5
    v_and_b32 v6, 7, v0
    v_lshl_add_u32 v5, v6, 4, v5
    s_lshl_b32 s75, s12, 10
    s_add_u32 m0, s75, 53248
    s_nop 0
    buffer_load_dwordx4 v5, s[44:47], s73 offen nt lds
    s_add_u32 m0, m0, 1024
    s_add_u32 s73, s73, 9216
    s_nop 0
    buffer_load_dwordx4 v5, s[44:47], s73 offen nt lds
    s_add_u32 m0, m0, 1024
    s_add_u32 s73, s73, 9216
    s_nop 0
    buffer_load_dwordx4 v5, s[44:47], s73 offen nt lds
    s_add_u32 m0, m0, 1024
    s_add_u32 s73, s73, 9216
    s_nop 0
    buffer_load_dwordx4 v5, s[44:47], s73 offen nt lds
Ltd_4:
    s_cmp_lg_u32 s3, 1
    s_cbranch_scc1 L_noml
    s_cmp_lg_u32 s3, 1
    s_cbranch_scc1 L_noml1
Lspin_8:
    ds_read_b32 v113, v112 offset:26760
    s_waitcnt lgkmcnt(0)
    v_readfirstlane_b32 s101, v113
    s_cmp_ge_u32 s101, 16
    s_cbranch_scc1 Lspind_9
    s_sleep 2
    s_branch Lspin_8
Lspind_9:
    v_and_b32 v32, 1, v2
    v_lshlrev_b32 v33, 3, v32
    v_lshl_add_u32 v33, v1, 4, v33
    ds_read_b64 v[24:25], v33 offset:25728
    v_and_b32 v33, 31, v0
    v_lshlrev_b32 v33, 2, v33
    v_lshlrev_b32 v32, 4, v32
    s_lshl_b32 s99, s72, 5
    s_add_u32 s99, s99, 8192
    s_waitcnt lgkmcnt(0)
    v_max_f32_dpp v26, v24, v24 row_ror:8 row_mask:0xf bank_mask:0xf
    s_nop 1
    v_max_f32_dpp v26, v26, v26 row_ror:4 row_mask:0xf bank_mask:0xf
    s_nop 1
    v_max_f32_dpp v26, v26, v26 row_ror:2 row_mask:0xf bank_mask:0xf
    s_nop 1
    v_max_f32_dpp v26, v26, v26 row_ror:1 row_mask:0xf bank_mask:0xf
    v_sub_f32 v27, v24, v26
    v_mul_f32 v27, s98, v27
    v_exp_f32 v27, v27
    s_nop 0
    ds_write_b32 v33, v27 offset:25984
    v_mul_f32 v25, v25, v27
    s_nop 1
    v_add_f32_dpp v25, v25, v25 row_ror:8 row_mask:0xf bank_mask:0xf
    s_nop 1
    v_add_f32_dpp v25, v25, v25 row_ror:4 row_mask:0xf bank_mask:0xf
    s_nop 1
    v_add_f32_dpp v25, v25, v25 row_ror:2 row_mask:0xf bank_mask:0xf
    s_nop 1
    v_add_f32_dpp v25, v25, v25 row_ror:1 row_mask:0xf bank_mask:0xf
    v_mov_b32 v30, s27
    v_mov_b32 v31, s27
    v_or_b32 v28, v26, v30
    v_and_or_b32 v29, v25, s97, v30
    s_mov_b64 exec, 0x10001
    s_cmp_eq_u32 s6, 0
    s_cbranch_scc1 Lrem_10
    buffer_store_dwordx4 v[28:31], v32, s[60:63], s99 offen
Lst_11:
    s_mov_b64 exec, -1
    s_branch L_noml
L_hipre:
L_noml1:
    s_waitcnt vmcnt(0)
L_noml:
    s_waitcnt lgkmcnt(0)
    s_barrier
    ds_read_b32 v12, v114 offset:25984
    ds_read_b128 v[8:11], v115 offset:9344
    s_waitcnt lgkmcnt(0)
    v_mul_f32 v8, v8, v12
    v_mul_f32 v9, v9, v12
    v_mul_f32 v10, v10, v12
    v_mul_f32 v11, v11, v12
    s_nop 1
    v_permlane32_swap_b32 v8, v9
    v_permlane32_swap_b32 v10, v11
    s_nop 0
    v_add_f32 v8, v8, v9
    v_add_f32 v10, v10, v11
    s_nop 1
    v_permlane16_swap_b32 v8, v10
    s_nop 0
    v_add_f32 v8, v8, v10
    s_nop 1
    v_add_f32_dpp v8, v8, v8 row_ror:4 row_mask:0xf bank_mask:0xf
    s_nop 1
    v_add_f32_dpp v8, v8, v8 row_ror:8 row_mask:0xf bank_mask:0xf
    v_and_or_b32 v8, v8, s97, v116
    s_mov_b64 exec, s[16:17]
    s_cmp_eq_u32 s6, 0
    s_cbranch_scc1 Lrem_12
    buffer_store_dword v8, v117, s[60:63], s76 offen
Lst_13:
    s_mov_b64 exec, 1
    ds_add_u32 v112, v118 offset:26792
    s_mov_b64 exec, -1
    s_cmp_lt_u32 s5, 14
    s_cbranch_scc1 L_noS2
    s_cmp_ge_u32 s3, 8
    s_cbranch_scc1 L_S2_hi
    s_setprio 2
    s_lshl_b32 s73, s8, 4
    s_lshl_b32 s75, s3, 1
    s_add_u32 s73, s73, s75
    s_lshl_b32 s76, s73, 10
    s_add_u32 s76, s76, 262144
    s_lshl_b32 s77, s73, 5
    s_add_u32 s77, s77, 8192
    v_lshlrev_b32 v5, 4, v0
    v_lshrrev_b32 v6, 5, v0
    v_lshlrev_b32 v6, 4, v6
    buffer_load_dwordx4 v[16:19], v6, s[60:63], s77 offen sc1
    buffer_load_dwordx4 v[20:23], v6, s[60:63], s77 offen offset:32 sc1
    buffer_load_dwordx4 v[8:11], v5, s[60:63], s76 offen sc1
    buffer_load_dwordx4 v[12:15], v5, s[60:63], s76 offen offset:1024 sc1
    s_waitcnt vmcnt(4)
    s_mov_b64 exec, 1
    ds_add_u32 v112, v118 offset:26768
    s_mov_b64 exec, -1
    s_branch L_pollM2
L_pollM:
    buffer_load_dwordx4 v[16:19], v6, s[60:63], s77 offen sc1
    buffer_load_dwordx4 v[20:23], v6, s[60:63], s77 offen offset:32 sc1
    buffer_load_dwordx4 v[8:11], v5, s[60:63], s76 offen sc1
    buffer_load_dwordx4 v[12:15], v5, s[60:63], s76 offen offset:1024 sc1
L_pollM2:
    s_waitcnt vmcnt(2)
    v_bitop3_b32 v26, v16, v17, s27 bitop3:0x7e
    v_bitop3_b32 v27, v18, v19, s27 bitop3:0x7e
    v_or_b32 v26, v26, v27
    v_bitop3_b32 v27, v20, v21, s27 bitop3:0x7e
    v_or_b32 v26, v26, v27
    v_bitop3_b32 v27, v22, v23, s27 bitop3:0x7e
    v_or_b32 v26, v26, v27
    v_and_b32 v26, 0xfff, v26
    v_cmp_ne_u32 vcc, 0, v26
    s_cbranch_vccz Lpd_14
    s_cmp_eq_u32 s74, 0
    s_cbranch_scc1 Lpd_14
    s_sub_u32 s74, s74, 1
    s_sleep 4
    s_branch L_pollM
Lpd_14:
    s_mul_i32 s73, s3, 528
    v_lshl_add_u32 v24, v6, 4, s73
    v_lshl_add_u32 v24, v1, 4, v24
    v_and_b32 v25, 1, v2
    v_lshl_add_u32 v24, v25, 3, v24
    v_and_b32 v16, s97, v16
    v_and_b32 v17, s97, v17
    v_and_b32 v20, s97, v20
    v_and_b32 v21, s97, v21
    v_max_f32 v30, v16, v20
    v_sub_f32 v28, v16, v30
    v_sub_f32 v29, v20, v30
    v_mul_f32 v28, s98, v28
    v_mul_f32 v29, s98, v29
    v_exp_f32 v28, v28
    v_exp_f32 v29, v29
    v_mov_b32 v31, 0
    v_mul_f32 v30, v28, v17
    v_fmac_f32 v30, v29, v21
    v_rcp_f32 v30, v30
    v_mov_b32 v32, 1
    v_mul_f32 v28, v28, v30
    v_mul_f32 v29, v29, v30
L_pollO:
    buffer_load_dwordx4 v[8:11], v5, s[60:63], s76 offen sc1
    buffer_load_dwordx4 v[12:15], v5, s[60:63], s76 offen offset:1024 sc1
    s_waitcnt vmcnt(2)
    v_bitop3_b32 v26, v8, v9, s27 bitop3:0x7e
    v_bitop3_b32 v27, v10, v11, s27 bitop3:0x7e
    v_or_b32 v26, v26, v27
    v_bitop3_b32 v27, v12, v13, s27 bitop3:0x7e
    v_or_b32 v26, v26, v27
    v_bitop3_b32 v27, v14, v15, s27 bitop3:0x7e
    v_or_b32 v26, v26, v27
    v_and_b32 v26, 0xfff, v26
    v_cmp_ne_u32 vcc, 0, v26
    s_cbranch_vccz Lpd_15
    s_mov_b64 exec, vcc
    s_cmp_eq_u32 s74, 0
    s_cbranch_scc1 Lpd_15
    s_sub_u32 s74, s74, 1
    s_branch L_pollO
Lpd_15:
    s_mov_b64 exec, -1
    v_and_b32 v40, s97, v8
    v_and_b32 v41, s97, v9
    v_and_b32 v42, s97, v10
    v_and_b32 v43, s97, v11
    v_and_b32 v44, s97, v12
    v_and_b32 v45, s97, v13
    v_and_b32 v46, s97, v14
    v_and_b32 v47, s97, v15
    v_mul_f32 v40, v40, v28
    v_mul_f32 v41, v41, v28
    v_mul_f32 v42, v42, v28
    v_mul_f32 v43, v43, v28
    v_fmac_f32 v40, v44, v29
    v_fmac_f32 v41, v45, v29
    v_fmac_f32 v42, v46, v29
    v_fmac_f32 v43, v47, v29
    v_cvt_pk_bf16_f32 v48, v40, v41
    v_cvt_pk_bf16_f32 v49, v42, v43
    ds_write_b64 v24, v[48:49] offset:27264
    s_mov_b64 exec, 1
    ds_add_u32 v31, v32 offset:26776
    s_mov_b64 exec, -1
    s_branch L_B1
L_S2_hi:
    s_sub_u32 s77, s3, 8
    s_cmp_ge_u32 s3, 12
    s_cbranch_scc1 L_S2_top
    v_mov_b32 v8, 0
    s_lshl_b32 s75, s77, 5
    v_lshl_add_u32 v5, v124, 7, v125
    v_add_u32 v5, s75, v5
    v_add_u32 v5, 53248, v5
Lspin_16:
    ds_read_b32 v9, v8 offset:26768
    s_waitcnt lgkmcnt(0)
    v_readfirstlane_b32 s101, v9
    s_cmp_ge_u32 s101, 8
    s_cbranch_scc0 Lspin_16
    ds_read_b64_tr_b16 v[56:57], v5 offset:0
    ds_read_b64_tr_b16 v[58:59], v5 offset:512
    ds_read_b64_tr_b16 v[60:61], v5 offset:4096
    ds_read_b64_tr_b16 v[62:63], v5 offset:4608
    ds_read_b64_tr_b16 v[64:65], v5 offset:8192
    ds_read_b64_tr_b16 v[66:67], v5 offset:8704
    ds_read_b64_tr_b16 v[68:69], v5 offset:12288
    ds_read_b64_tr_b16 v[70:71], v5 offset:12800
    ds_read_b64_tr_b16 v[72:73], v5 offset:16384
    ds_read_b64_tr_b16 v[74:75], v5 offset:16896
    ds_read_b64_tr_b16 v[76:77], v5 offset:20480
    ds_read_b64_tr_b16 v[78:79], v5 offset:20992
    ds_read_b64_tr_b16 v[80:81], v5 offset:24576
    ds_read_b64_tr_b16 v[82:83], v5 offset:25088
    ds_read_b64_tr_b16 v[84:85], v5 offset:28672
    ds_read_b64_tr_b16 v[86:87], v5 offset:29184
    v_mul_u32_u24 v6, 528, v126
    v_lshl_add_u32 v6, v2, 4, v6
    v_lshlrev_b32 v7, 6, v1
    v_lshl_add_u32 v7, v2, 4, v7
    s_mul_i32 s76, s8, 18432
    s_lshl_b32 s75, s9, 11
    s_add_u32 s76, s76, s75
    s_lshl_b32 s75, s77, 9
    s_add_u32 s76, s76, s75
    s_add_u32 s76, s76, 524288
    v_mov_b32 v10, s27
    s_waitcnt lgkmcnt(0)
Lspin_18:
    ds_read_b32 v9, v8 offset:26776
    s_waitcnt lgkmcnt(0)
    v_readfirstlane_b32 s101, v9
    s_cmp_ge_u32 s101, 8
    s_cbranch_scc0 Lspin_18
    ds_read_b128 v[88:91], v6 offset:27264
    ds_read_b128 v[92:95], v6 offset:27328
    ds_read_b128 v[96:99], v6 offset:27392
    ds_read_b128 v[100:103], v6 offset:27456
    ds_read_b128 v[104:107], v6 offset:27520
    ds_read_b128 v[108:111], v6 offset:27584
    ds_read_b128 v[112:115], v6 offset:27648
    ds_read_b128 v[116:119], v6 offset:27712
    s_waitcnt lgkmcnt(7)
    v_mfma_f32_16x16x32_bf16 v[120:123], v[56:59], v[88:91], 0
    s_waitcnt lgkmcnt(6)
    v_mfma_f32_16x16x32_bf16 v[120:123], v[60:63], v[92:95], v[120:123]
    s_waitcnt lgkmcnt(5)
    v_mfma_f32_16x16x32_bf16 v[120:123], v[64:67], v[96:99], v[120:123]
    s_waitcnt lgkmcnt(4)
    v_mfma_f32_16x16x32_bf16 v[120:123], v[68:71], v[100:103], v[120:123]
    s_waitcnt lgkmcnt(3)
    v_mfma_f32_16x16x32_bf16 v[120:123], v[72:75], v[104:107], v[120:123]
    s_waitcnt lgkmcnt(2)
    v_mfma_f32_16x16x32_bf16 v[120:123], v[76:79], v[108:111], v[120:123]
    s_waitcnt lgkmcnt(1)
    v_mfma_f32_16x16x32_bf16 v[120:123], v[80:83], v[112:115], v[120:123]
    s_waitcnt lgkmcnt(0)
    v_mfma_f32_16x16x32_bf16 v[120:123], v[84:87], v[116:119], v[120:123]
    s_mov_b64 exec, s[14:15]
    s_nop 6
    v_and_or_b32 v12, v120, s97, v10
    v_and_or_b32 v13, v121, s97, v10
    v_and_or_b32 v14, v122, s97, v10
    v_and_or_b32 v15, v123, s97, v10
    buffer_store_dwordx4 v[12:15], v7, s[60:63], s76 offen sc1
    s_mov_b64 exec, -1
    s_branch L_fin
L_S2_top:
    s_cmp_lt_u32 s5, 22
    s_cbranch_scc1 L_M2
    s_cmp_lt_u32 s5, 23
    s_cbranch_scc1 L_fin
    s_cmp_ge_u32 s3, 14
    s_cbranch_scc1 L_fin
    s_lshl_b32 s73, s5, 1
    s_add_u32 s73, s73, s3
    s_sub_u32 s73, s73, 58
    s_lshl_b32 s73, s73, 3
    s_add_u32 s73, s73, s4
    s_lshl_b32 s12, s73, 7
    s_and_b32 s75, s73, 3
    s_lshr_b32 s73, s73, 2
    s_mul_i32 s75, s75, 2304
    s_lshl_b32 s73, s73, 5
    s_add_u32 s11, s73, s75
    v_lshl_add_u32 v21, v126, 4, v127
    v_lshrrev_b32 v22, 2, v126
    v_mul_u32_u24 v30, 2240, v22
    v_add_u32 v30, v30, v21
    v_lshrrev_b32 v22, 1, v30
    v_lshrrev_b32 v20, 3, v0
    v_mul_u32_u24 v5, 18432, v20
    v_lshl_add_u32 v5, v126, 4, v5
    s_mul_i32 s75, s4, 18432
    s_lshl_b32 s73, s11, 1
    s_add_u32 s78, s75, s73
    s_add_u32 s78, s78, 32768
    s_add_u32 s76, s12, 819200
    s_add_u32 s77, s12, 966656
    v_mov_b32 v8, 0
Lspin_20:
    ds_read_b32 v9, v8 offset:26788
    s_waitcnt lgkmcnt(0)
    v_readfirstlane_b32 s101, v9
    s_cmp_ge_u32 s101, 8
    s_cbranch_scc1 Lspind_21
    s_sleep 4
    s_branch Lspin_20
Lspind_21:
L_pollh:
    buffer_load_dword v25, v30, s[60:63], s78 offen sc1
    s_waitcnt vmcnt(0)
    v_xor_b32 v26, s27, v25
    v_and_b32 v26, 0xfff, v26
    v_cmp_ne_u32 vcc, 0, v26
    s_cbranch_vccz Lpd_22
    s_cmp_eq_u32 s74, 0
    s_cbranch_scc1 Lpd_22
    s_sub_u32 s74, s74, 1
    s_sleep 2
    s_branch L_pollh
Lpd_22:
    s_cmp_lg_u32 s12, 0
    s_cbranch_scc1 Lnoep_23
    s_add_u32 s73, s26, 1
    v_mov_b32 v50, s73
    v_mov_b32 v51, 0
    s_mov_b64 exec, 1
    buffer_store_dword v50, v51, s[60:63], 0 offen offset:0 sc1
    s_mov_b64 exec, -1
Lnoep_23:
    v_and_b32 v31, s96, v25
    s_waitcnt vmcnt(0)
L_pollX:
    buffer_load_dwordx4 v[8:11], v5, s[60:63], s76 offen sc1
    buffer_load_dwordx4 v[12:15], v5, s[60:63], s77 offen sc1
    s_waitcnt vmcnt(0)
    v_bitop3_b32 v26, v8, v9, s27 bitop3:0x7e
    v_bitop3_b32 v27, v10, v11, s27 bitop3:0x7e
    v_or_b32 v26, v26, v27
    v_bitop3_b32 v27, v12, v13, s27 bitop3:0x7e
    v_or_b32 v26, v26, v27
    v_bitop3_b32 v27, v14, v15, s27 bitop3:0x7e
    v_or_b32 v26, v26, v27
    v_and_b32 v26, 0xfff, v26
    v_cmp_ne_u32 vcc, 0, v26
    s_cbranch_vccz Lpd_24
    s_mov_b64 exec, vcc
    s_cmp_eq_u32 s74, 0
    s_cbranch_scc1 Lpd_24
    s_sub_u32 s74, s74, 1
    s_branch L_pollX
Lpd_24:
    s_mov_b64 exec, -1
    v_and_b32 v40, s97, v8
    v_and_b32 v41, s97, v9
    v_and_b32 v42, s97, v10
    v_and_b32 v43, s97, v11
    v_and_b32 v44, s97, v12
    v_and_b32 v45, s97, v13
    v_and_b32 v46, s97, v14
    v_and_b32 v47, s97, v15
    v_add_f32 v40, v40, v44
    v_add_f32 v41, v41, v45
    v_add_f32 v42, v42, v46
    v_add_f32 v43, v43, v47
    s_nop 1
    v_permlane32_swap_b32 v40, v41
    v_permlane32_swap_b32 v42, v43
    s_nop 0
    v_add_f32 v40, v40, v41
    v_add_f32 v42, v42, v43
    s_nop 1
    v_permlane16_swap_b32 v40, v42
    s_nop 0
    v_add_f32 v40, v40, v42
    s_nop 1
    v_add_f32_dpp v40, v40, v40 row_ror:8 row_mask:0xf bank_mask:0xf
    v_cvt_pk_bf16_f32 v40, v40, v40
    v_and_b32 v40, s96, v40
    v_add_f32 v40, v40, v31
    v_cvt_pk_bf16_f32 v40, v40, v40
    s_mov_b64 exec, s[14:15]
    buffer_store_short v40, v22, s[56:59], s11 offen
    s_mov_b64 exec, -1
    s_branch L_fin
L_B1:
    s_lshl_b32 s73, s5, 3
    s_add_u32 s73, s73, s3
    s_sub_u32 s73, s73, 112
    s_lshl_b32 s12, s73, 7
    s_and_b32 s75, s73, 3
    s_lshr_b32 s73, s73, 2
    s_mul_i32 s75, s75, 2304
    s_lshl_b32 s73, s73, 5
    s_add_u32 s11, s73, s75
    v_lshl_add_u32 v21, v126, 4, v127
    v_lshrrev_b32 v22, 2, v126
    v_mul_u32_u24 v30, 2240, v22
    v_add_u32 v30, v30, v21
    v_lshrrev_b32 v22, 1, v30
    v_lshrrev_b32 v20, 3, v0
    v_mul_u32_u24 v5, 18432, v20
    v_lshl_add_u32 v5, v126, 4, v5
    s_mul_i32 s75, s4, 18432
    s_lshl_b32 s73, s11, 1
    s_add_u32 s78, s75, s73
    s_add_u32 s78, s78, 32768
    s_waitcnt vmcnt(0)
    buffer_load_ushort v23, v22, s[28:31], s11 offen
    s_add_u32 s76, s12, 524288
    s_add_u32 s77, s12, 671744
    v_mov_b32 v24, s27
Lspin_25:
    ds_read_b32 v33, v31 offset:26776
    s_waitcnt lgkmcnt(0)
    v_readfirstlane_b32 s101, v33
    s_cmp_ge_u32 s101, 8
    s_cbranch_scc1 Lspind_26
    s_sleep 2
    s_branch Lspin_25
Lspind_26:
L_pollP:
    buffer_load_dwordx4 v[8:11], v5, s[60:63], s76 offen sc1
    buffer_load_dwordx4 v[12:15], v5, s[60:63], s77 offen sc1
    s_waitcnt vmcnt(0)
    v_bitop3_b32 v26, v8, v9, s27 bitop3:0x7e
    v_bitop3_b32 v27, v10, v11, s27 bitop3:0x7e
    v_or_b32 v26, v26, v27
    v_bitop3_b32 v27, v12, v13, s27 bitop3:0x7e
    v_or_b32 v26, v26, v27
    v_bitop3_b32 v27, v14, v15, s27 bitop3:0x7e
    v_or_b32 v26, v26, v27
    v_and_b32 v26, 0xfff, v26
    v_cmp_ne_u32 vcc, 0, v26
    s_cbranch_vccz Lpd_27
    s_mov_b64 exec, vcc
    s_cmp_eq_u32 s74, 0
    s_cbranch_scc1 Lpd_27
    s_sub_u32 s74, s74, 1
    s_branch L_pollP
Lpd_27:
    s_mov_b64 exec, -1
    v_and_b32 v40, s97, v8
    v_and_b32 v41, s97, v9
    v_and_b32 v42, s97, v10
    v_and_b32 v43, s97, v11
    v_and_b32 v44, s97, v12
    v_and_b32 v45, s97, v13
    v_and_b32 v46, s97, v14
    v_and_b32 v47, s97, v15
    v_add_f32 v40, v40, v44
    v_add_f32 v41, v41, v45
    v_add_f32 v42, v42, v46
    v_add_f32 v43, v43, v47
    v_lshlrev_b32 v23, 16, v23
    s_nop 1
    v_permlane32_swap_b32 v40, v41
    v_permlane32_swap_b32 v42, v43
    s_nop 0
    v_add_f32 v40, v40, v41
    v_add_f32 v42, v42, v43
    s_nop 1
    v_permlane16_swap_b32 v40, v42
    s_nop 0
    v_add_f32 v40, v40, v42
    s_nop 1
    v_add_f32_dpp v40, v40, v40 row_ror:8 row_mask:0xf bank_mask:0xf
    v_cvt_pk_bf16_f32 v40, v40, v40
    v_and_b32 v40, s96, v40
    v_add_f32 v40, v40, v23
    v_cvt_pk_bf16_f32 v40, v40, v40
    v_and_or_b32 v25, v40, s96, v24
    s_mov_b64 exec, s[14:15]
    s_cmp_eq_u32 s6, 0
    s_cbranch_scc1 Lrem_28
    buffer_store_dword v25, v30, s[60:63], s78 offen
Lst_29:
    s_mov_b64 exec, 1
    ds_add_u32 v31, v32 offset:26788
    s_mov_b64 exec, -1
    s_cmp_lt_u32 s5, 22
    s_cbranch_scc1 L_G2pre
    s_branch L_fin
L_noS2:
    s_cmp_ge_u32 s3, 12
    s_cbranch_scc1 L_M1
    s_cmp_ge_u32 s3, 8
    s_cbranch_scc1 L_M23
    s_and_b32 s75, s5, 1
    s_mul_i32 s75, s75, 1152
    s_mul_i32 s78, s4, 36864
    s_add_u32 s78, s78, s75
    s_mul_i32 s75, s3, 2304
    s_add_u32 s78, s78, s75
    s_add_u32 s78, s78, 1114112
    s_add_u32 s79, s78, 18432
    v_lshlrev_b32 v5, 4, v0
    v_lshlrev_b32 v7, 4, v126
L_G1:
    s_setprio 2
    s_mul_i32 s76, s4, 18432
    s_mul_i32 s73, s3, 2304
    s_add_u32 s76, s76, s73
    s_add_u32 s76, s76, 32768
    v_lshlrev_b32 v5, 4, v0
    v_lshlrev_b32 v6, 2, v0
    v_mov_b32 v31, 0
    v_mov_b32 v32, 1
L_pollH0:
    buffer_load_dword v72, v6, s[60:63], s76 offen offset:2048 sc1
    s_waitcnt vmcnt(0)
    v_xor_b32 v26, s27, v72
    v_and_b32 v26, 0xfff, v26
    v_cmp_eq_u32 vcc, 0, v26
    s_bcnt1_i32_b64 s73, vcc
    s_cmp_ge_u32 s73, 16
    s_cbranch_scc1 L_pollH1
    s_cmp_eq_u32 s74, 0
    s_cbranch_scc1 L_pollH1
    s_sub_u32 s74, s74, 1
    s_sleep 4
    s_branch L_pollH0
L_pollH1:
    s_mov_b64 s[18:19], -1
L_pollH:
    buffer_load_dword v72, v6, s[60:63], s76 offen offset:2048 sc1
    s_mov_b64 exec, s[18:19]
    buffer_load_dwordx4 v[64:67], v5, s[60:63], s76 offen sc1
    buffer_load_dwordx4 v[68:71], v5, s[60:63], s76 offen offset:1024 sc1
    s_mov_b64 exec, -1
    s_waitcnt vmcnt(0)
    v_bitop3_b32 v26, v64, v65, s27 bitop3:0x7e
    v_bitop3_b32 v27, v66, v67, s27 bitop3:0x7e
    v_or_b32 v26, v26, v27
    v_bitop3_b32 v27, v68, v69, s27 bitop3:0x7e
    v_or_b32 v26, v26, v27
    v_bitop3_b32 v27, v70, v71, s27 bitop3:0x7e
    v_or_b32 v26, v26, v27
    v_xor_b32 v27, s27, v72
    v_and_b32 v26, 0xfff, v26
    v_and_b32 v27, 0xfff, v27
    v_cmp_ne_u32 s[18:19], 0, v26
    v_cmp_ne_u32 vcc, 0, v27
    s_or_b64 vcc, vcc, s[18:19]
    s_cbranch_scc0 L_pollHd
    s_or_b32 s18, s18, 1
    s_cmp_eq_u32 s74, 0
    s_cbranch_scc1 L_pollHd
    s_sub_u32 s74, s74, 1
    s_branch L_pollH
L_pollHd:
    v_and_b32 v8, s96, v64
    v_and_b32 v9, s96, v65
    v_and_b32 v10, s96, v66
    v_and_b32 v11, s96, v67
    v_and_b32 v12, s96, v68
    v_and_b32 v13, s96, v69
    v_and_b32 v14, s96, v70
    v_and_b32 v15, s96, v71
    v_and_b32 v16, s96, v72
    v_readfirstlane_b32 s100, v8
    s_mul_i32 s73, s3, 1168
    s_nop 0
    v_pk_add_f32 v[40:41], v[8:9], s[100:101] op_sel_hi:[1,0] neg_lo:[0,1] neg_hi:[0,1]
    v_pk_add_f32 v[42:43], v[10:11], s[100:101] op_sel_hi:[1,0] neg_lo:[0,1] neg_hi:[0,1]
    v_pk_add_f32 v[44:45], v[12:13], s[100:101] op_sel_hi:[1,0] neg_lo:[0,1] neg_hi:[0,1]
    v_pk_add_f32 v[46:47], v[14:15], s[100:101] op_sel_hi:[1,0] neg_lo:[0,1] neg_hi:[0,1]
    v_subrev_f32 v48, s100, v16
    v_pk_add_f32 v[50:51], v[40:41], v[42:43]
    v_pk_mul_f32 v[52:53], v[40:41], v[40:41]
    v_pk_add_f32 v[54:55], v[44:45], v[46:47]
    v_pk_fma_f32 v[52:53], v[42:43], v[42:43], v[52:53]
    v_pk_add_f32 v[50:51], v[50:51], v[54:55]
    v_pk_fma_f32 v[52:53], v[44:45], v[44:45], v[52:53]
    v_add_f32 v50, v50, v51
    v_pk_fma_f32 v[52:53], v[46:47], v[46:47], v[52:53]
    v_add_f32 v50, v50, v48
    v_add_f32 v52, v52, v53
    v_fmac_f32 v52, v48, v48
    s_mov_b32 s99, s100
    s_nop 0
    v_permlane32_swap_b32 v50, v52
    s_nop 0
    v_add_f32 v54, v50, v52
    v_add_f32 v55, v50, v52
    s_nop 1
    v_permlane16_swap_b32 v54, v55
    s_nop 0
    v_add_f32 v54, v54, v55
    s_nop 1
    v_add_f32_dpp v54, v54, v54 row_ror:8 row_mask:0xf bank_mask:0xf
    s_nop 1
    v_add_f32_dpp v54, v54, v54 row_ror:4 row_mask:0xf bank_mask:0xf
    s_nop 1
    v_add_f32_dpp v54, v54, v54 row_ror:2 row_mask:0xf bank_mask:0xf
    s_nop 1
    v_add_f32_dpp v54, v54, v54 row_ror:1 row_mask:0xf bank_mask:0xf
    v_mov_b32 v55, 0x3ae38e39
    v_readlane_b32 s100, v54, 0
    v_readlane_b32 s101, v54, 32
    s_nop 0
    v_mul_f32 v50, s100, v55
    v_mul_f32 v52, s101, v55
    v_add_f32 v54, s99, v50
    v_fma_f32 v52, -v50, v50, v52
    v_max_f32 v52, 0, v52
    v_cvt_pk_bf16_f32 v55, v54, v52
    v_lshlrev_b32 v54, 16, v55
    v_and_b32 v52, s96, v55
    v_add_f32 v52, 0x3727c5ac, v52
    v_cvt_pk_bf16_f32 v52, v52, v52
    v_and_b32 v52, s96, v52
    v_sqrt_f32 v52, v52
    v_pk_add_f32 v[40:41], v[8:9], v[54:55] op_sel_hi:[1,0] neg_lo:[0,1] neg_hi:[0,1]
    v_pk_add_f32 v[42:43], v[10:11], v[54:55] op_sel_hi:[1,0] neg_lo:[0,1] neg_hi:[0,1]
    v_pk_add_f32 v[44:45], v[12:13], v[54:55] op_sel_hi:[1,0] neg_lo:[0,1] neg_hi:[0,1]
    v_pk_add_f32 v[46:47], v[14:15], v[54:55] op_sel_hi:[1,0] neg_lo:[0,1] neg_hi:[0,1]
    v_sub_f32 v48, v16, v54
    v_cvt_pk_bf16_f32 v52, v52, v52
    v_and_b32 v52, s96, v52
    v_rcp_f32 v52, v52
    v_cvt_pk_bf16_f32 v8, v40, v41
    v_cvt_pk_bf16_f32 v10, v42, v43
    v_cvt_pk_bf16_f32 v12, v44, v45
    v_cvt_pk_bf16_f32 v14, v46, v47
    v_cvt_pk_bf16_f32 v16, v48, v48
    v_lshl_add_u32 v50, v0, 3, s73
    v_lshl_add_u32 v55, v0, 1, s73
    v_lshlrev_b32 v40, 16, v8
    v_and_b32 v41, s96, v8
    v_lshlrev_b32 v42, 16, v10
    v_and_b32 v43, s96, v10
    v_pk_mul_f32 v[40:41], v[40:41], v[52:53] op_sel_hi:[1,0]
    v_pk_mul_f32 v[42:43], v[42:43], v[52:53] op_sel_hi:[1,0]
    v_cvt_pk_bf16_f32 v8, v40, v41
    v_cvt_pk_bf16_f32 v9, v42, v43
    ds_write_b64 v50, v[8:9] offset:0
    v_lshlrev_b32 v44, 16, v12
    v_and_b32 v45, s96, v12
    v_lshlrev_b32 v46, 16, v14
    v_and_b32 v47, s96, v14
    v_pk_mul_f32 v[44:45], v[44:45], v[52:53] op_sel_hi:[1,0]
    v_pk_mul_f32 v[46:47], v[46:47], v[52:53] op_sel_hi:[1,0]
    v_cvt_pk_bf16_f32 v12, v44, v45
    v_cvt_pk_bf16_f32 v13, v46, v47
    ds_write_b64 v50, v[12:13] offset:512
    v_lshlrev_b32 v48, 16, v16
    v_mul_f32 v48, v48, v52
    v_cvt_pk_bf16_f32 v16, v48, v48
    ds_write_b16 v55, v16 offset:1024
    s_mov_b64 exec, 1
    ds_add_u32 v31, v32 offset:26764
    s_mov_b64 exec, -1
    s_cmp_lt_u32 s5, 4
    s_cbranch_scc1 L_fin
Lspin_30:
    ds_read_b32 v33, v31 offset:26796
    s_waitcnt lgkmcnt(0)
    v_readfirstlane_b32 s101, v33
    s_cmp_ge_u32 s101, 4
    s_cbranch_scc1 Lspind_31
    s_sleep 1
    s_branch Lspin_30
Lspind_31:
    s_branch L_G2
L_G2pre:
    s_setprio 2
    s_and_b32 s75, s5, 1
    s_mul_i32 s75, s75, 1152
    s_mul_i32 s78, s4, 36864
    s_add_u32 s78, s78, s75
    s_mul_i32 s75, s3, 2304
    s_add_u32 s78, s78, s75
    s_add_u32 s78, s78, 1114112
    s_add_u32 s79, s78, 18432
    v_lshlrev_b32 v5, 4, v0
    v_lshlrev_b32 v7, 4, v126
    v_mov_b32 v31, 0
    v_mov_b32 v32, 1
L_pollG0:
    buffer_load_dwordx4 v[88:91], v7, s[60:63], s78 offen offset:1024 sc1
    s_waitcnt vmcnt(0)
    v_bitop3_b32 v26, v88, v89, s27 bitop3:0x7e
    v_bitop3_b32 v27, v90, v91, s27 bitop3:0x7e
    v_or_b32 v26, v26, v27
    v_and_b32 v26, 0xfff, v26
    v_cmp_ne_u32 vcc, 0, v26
    s_cbranch_vccz Lpd_32
    s_cmp_eq_u32 s74, 0
    s_cbranch_scc1 Lpd_32
    s_sub_u32 s74, s74, 1
    s_sleep 2
    s_branch L_pollG0
Lpd_32:
L_G2:
    s_mul_i32 s73, s3, 1168
    v_lshl_add_u32 v28, v0, 3, s73
    s_waitcnt vmcnt(0)
L_pollG:
    buffer_load_dwordx4 v[80:83], v5, s[60:63], s78 offen sc1
    buffer_load_dwordx4 v[84:87], v5, s[60:63], s79 offen sc1
    buffer_load_dwordx4 v[88:91], v7, s[60:63], s78 offen offset:1024 sc1
    buffer_load_dwordx4 v[92:95], v7, s[60:63], s79 offen offset:1024 sc1
    s_waitcnt vmcnt(0)
    v_bitop3_b32 v26, v80, v81, s27 bitop3:0x7e
    v_bitop3_b32 v27, v82, v83, s27 bitop3:0x7e
    v_or_b32 v26, v26, v27
    v_bitop3_b32 v27, v84, v85, s27 bitop3:0x7e
    v_or_b32 v26, v26, v27
    v_bitop3_b32 v27, v86, v87, s27 bitop3:0x7e
    v_or_b32 v26, v26, v27
    v_bitop3_b32 v27, v88, v89, s27 bitop3:0x7e
    v_or_b32 v26, v26, v27
    v_bitop3_b32 v27, v90, v91, s27 bitop3:0x7e
    v_or_b32 v26, v26, v27
    v_bitop3_b32 v27, v92, v93, s27 bitop3:0x7e
    v_or_b32 v26, v26, v27
    v_bitop3_b32 v27, v94, v95, s27 bitop3:0x7e
    v_or_b32 v26, v26, v27
    v_and_b32 v26, 0xfff, v26
    v_cmp_ne_u32 vcc, 0, v26
    s_cbranch_vccz Lpd_33
    s_mov_b64 exec, vcc
    s_cmp_eq_u32 s74, 0
    s_cbranch_scc1 Lpd_33
    s_sub_u32 s74, s74, 1
    s_branch L_pollG
Lpd_33:
    s_mov_b64 exec, -1
    v_and_b32 v40, s97, v80
    v_and_b32 v41, s97, v81
    v_and_b32 v42, s97, v82
    v_and_b32 v43, s97, v83
    v_and_b32 v44, s97, v84
    v_and_b32 v45, s97, v85
    v_and_b32 v46, s97, v86
    v_and_b32 v47, s97, v87
    v_and_b32 v48, s97, v88
    v_and_b32 v49, s97, v89
    v_and_b32 v50, s97, v90
    v_and_b32 v51, s97, v91
    v_and_b32 v52, s97, v92
    v_and_b32 v53, s97, v93
    v_and_b32 v54, s97, v94
    v_and_b32 v55, s97, v95
    v_add_f32 v40, v40, v44
    v_add_f32 v41, v41, v45
    v_add_f32 v42, v42, v46
    v_add_f32 v43, v43, v47
    v_max_f32 v40, 0, v40
    v_max_f32 v41, 0, v41
    v_max_f32 v42, 0, v42
    v_max_f32 v43, 0, v43
    v_cvt_pk_bf16_f32 v8, v40, v41
    v_cvt_pk_bf16_f32 v9, v42, v43
    ds_write_b64 v28, v[8:9] offset:33792
    v_add_f32 v48, v48, v52
    v_add_f32 v49, v49, v53
    v_add_f32 v50, v50, v54
    v_add_f32 v51, v51, v55
    v_max_f32 v48, 0, v48
    v_max_f32 v49, 0, v49
    v_max_f32 v50, 0, v50
    v_max_f32 v51, 0, v51
    v_cvt_pk_bf16_f32 v10, v48, v49
    v_cvt_pk_bf16_f32 v11, v50, v51
    s_mov_b64 exec, 0xff
    ds_write_b64 v28, v[10:11] offset:34304
    s_mov_b64 exec, 1
    ds_add_u32 v31, v32 offset:26780
    s_mov_b64 exec, -1
    s_branch L_fin
L_M1:
    s_cmp_lg_u32 s3, 12
    s_cbranch_scc1 Lnt_34
    s_cmp_ge_u32 s5, 9
    s_cbranch_scc1 Lnt_34
    s_mul_i32 s73, s5, 6144
    s_mul_i32 s75, s4, 18432
    s_add_u32 s10, s75, 32768
    s_cmp_lt_u32 s5, 3
    s_cbranch_scc1 Lnt2_35
    s_lshl_b32 s75, s75, 1
    s_add_u32 s10, s75, 1095680
Lnt2_35:
    s_add_u32 s10, s10, s73
    v_lshlrev_b32 v5, 7, v0
    v_mov_b32 v116, 0
Lspin_36:
    ds_read_b32 v119, v116 offset:26792
    s_waitcnt lgkmcnt(0)
    v_readfirstlane_b32 s101, v119
    s_cmp_ge_u32 s101, 16
    s_cbranch_scc1 Lspind_37
    s_sleep 1
    s_branch Lspin_36
Lspind_37:
    s_mov_b32 exec_hi, 0xffff
    buffer_load_dword v115, v5, s[60:63], s10 offen sc1
    s_mov_b64 exec, -1
Lnt_34:
    v_mov_b32 v116, 0
    v_mov_b32 v117, 1
    v_mov_b32 v118, s27
    s_add_u32 s9, s5, 0
    s_lshr_b32 s8, s9, 1
    s_and_b32 s9, s9, 1
    s_lshl_b32 s11, s8, 7
    s_mul_i32 s73, s4, 1152
    s_add_u32 s11, s11, s73
    s_mul_i32 s73, s9, 2654208
    s_add_u32 s11, s11, s73
    s_and_b32 s10, s3, 3
    s_mul_i32 s12, s10, 9
Lspin_38:
    ds_read_b32 v119, v116 offset:26792
    s_waitcnt lgkmcnt(0)
    v_readfirstlane_b32 s101, v119
    s_cmp_ge_u32 s101, 16
    s_cbranch_scc1 Lspind_39
    s_sleep 1
    s_branch Lspin_38
Lspind_39:
    s_mul_i32 s75, s12, 73728
    s_add_u32 s73, s11, s75
    v_lshrrev_b32 v5, 3, v0
    v_mul_u32_u24 v5, 9216, v5
    v_lshl_add_u32 v5, v126, 4, v5
    s_lshl_b32 s75, s12, 10
    s_add_u32 m0, s75, 86016
    s_nop 0
    buffer_load_dwordx4 v5, s[48:51], s73 offen nt lds
    s_add_u32 m0, m0, 1024
    s_add_u32 s73, s73, 73728
    s_nop 0
    buffer_load_dwordx4 v5, s[48:51], s73 offen nt lds
    s_add_u32 m0, m0, 1024
    s_add_u32 s73, s73, 73728
    s_nop 0
    buffer_load_dwordx4 v5, s[48:51], s73 offen nt lds
    s_add_u32 m0, m0, 1024
    s_add_u32 s73, s73, 73728
    s_nop 0
    buffer_load_dwordx4 v5, s[48:51], s73 offen nt lds
    s_add_u32 m0, m0, 1024
    s_add_u32 s73, s73, 73728
    s_nop 0
    buffer_load_dwordx4 v5, s[48:51], s73 offen nt lds
    s_add_u32 m0, m0, 1024
    s_add_u32 s73, s73, 73728
    s_nop 0
    buffer_load_dwordx4 v5, s[48:51], s73 offen nt lds
    s_add_u32 m0, m0, 1024
    s_add_u32 s73, s73, 73728
    s_nop 0
    buffer_load_dwordx4 v5, s[48:51], s73 offen nt lds
    s_add_u32 m0, m0, 1024
    s_add_u32 s73, s73, 73728
    s_nop 0
    buffer_load_dwordx4 v5, s[48:51], s73 offen nt lds
    s_add_u32 m0, m0, 1024
    s_add_u32 s73, s73, 73728
    s_nop 0
    buffer_load_dwordx4 v5, s[48:51], s73 offen nt lds
    s_mov_b64 exec, 1
    ds_add_u32 v116, v117 offset:26768
    s_mov_b64 exec, -1
    s_lshl_b32 s75, s10, 5
    s_add_u32 s75, s75, 86016
    v_lshl_add_u32 v5, v124, 7, v125
    v_add_u32 v5, s75, v5
    v_mul_u32_u24 v6, 1168, v126
    v_lshl_add_u32 v6, v2, 4, v6
    s_lshl_b32 s76, s4, 1
    s_add_u32 s76, s76, s9
    s_mul_i32 s76, s76, 18432
    s_mul_i32 s73, s9, 576
    v_add_u32 v6, s73, v6
    v_mul_u32_u24 v7, 2304, v1
    v_lshl_add_u32 v7, v2, 4, v7
    s_lshl_b32 s75, s8, 8
    s_add_u32 s76, s76, s75
    s_lshl_b32 s75, s10, 6
    s_add_u32 s76, s76, s75
    s_add_u32 s76, s76, 1114112
    s_waitcnt vmcnt(0)
    s_mov_b64 exec, 1
    ds_add_u32 v116, v117 offset:26772
    s_mov_b64 exec, -1
Lspin_40:
    ds_read_b32 v119, v116 offset:26772
    s_waitcnt lgkmcnt(0)
    v_readfirstlane_b32 s101, v119
    s_cmp_ge_u32 s101, 4
    s_cbranch_scc1 Lspind_41
    s_sleep 1
    s_branch Lspin_40
Lspind_41:
    ds_read_b64_tr_b16 v[8:9], v5 offset:0
    ds_read_b64_tr_b16 v[10:11], v5 offset:512
    ds_read_b64_tr_b16 v[12:13], v5 offset:4096
    ds_read_b64_tr_b16 v[14:15], v5 offset:4608
    ds_read_b64_tr_b16 v[16:17], v5 offset:8192
    ds_read_b64_tr_b16 v[18:19], v5 offset:8704
    ds_read_b64_tr_b16 v[20:21], v5 offset:12288
    ds_read_b64_tr_b16 v[22:23], v5 offset:12800
    ds_read_b64_tr_b16 v[24:25], v5 offset:16384
    ds_read_b64_tr_b16 v[26:27], v5 offset:16896
    s_waitcnt lgkmcnt(0)
    ds_read_b64_tr_b16 v[28:29], v5 offset:20480
    ds_read_b64_tr_b16 v[30:31], v5 offset:20992
    ds_read_b64_tr_b16 v[32:33], v5 offset:24576
    ds_read_b64_tr_b16 v[34:35], v5 offset:25088
    ds_read_b64_tr_b16 v[36:37], v5 offset:28672
    ds_read_b64_tr_b16 v[38:39], v5 offset:29184
    ds_read_b64_tr_b16 v[40:41], v5 offset:32768
    ds_read_b64_tr_b16 v[42:43], v5 offset:33280
Lspin_42:
    ds_read_b32 v119, v116 offset:26764
    s_waitcnt lgkmcnt(0)
    v_readfirstlane_b32 s101, v119
    s_cmp_ge_u32 s101, 1
    s_cbranch_scc1 Lspind_43
    s_sleep 2
    s_branch Lspin_42
Lspind_43:
Lspin_44:
    ds_read_b32 v119, v116 offset:26764
    s_waitcnt lgkmcnt(0)
    v_readfirstlane_b32 s101, v119
    s_cmp_ge_u32 s101, 8
    s_cbranch_scc0 Lspin_44
    ds_read_b128 v[48:51], v6 offset:0
    ds_read_b128 v[52:55], v6 offset:64
    ds_read_b128 v[56:59], v6 offset:128
    ds_read_b128 v[60:63], v6 offset:192
    ds_read_b128 v[64:67], v6 offset:256
    ds_read_b128 v[68:71], v6 offset:320
    ds_read_b128 v[72:75], v6 offset:384
    ds_read_b128 v[76:79], v6 offset:448
    ds_read_b128 v[80:83], v6 offset:512
    s_waitcnt lgkmcnt(8)
    v_mfma_f32_16x16x32_bf16 v[120:123], v[8:11], v[48:51], 0
    s_waitcnt lgkmcnt(7)
    v_mfma_f32_16x16x32_bf16 v[120:123], v[12:15], v[52:55], v[120:123]
    s_waitcnt lgkmcnt(6)
    v_mfma_f32_16x16x32_bf16 v[120:123], v[16:19], v[56:59], v[120:123]
    s_waitcnt lgkmcnt(5)
    v_mfma_f32_16x16x32_bf16 v[120:123], v[20:23], v[60:63], v[120:123]
    s_waitcnt lgkmcnt(4)
    v_mfma_f32_16x16x32_bf16 v[120:123], v[24:27], v[64:67], v[120:123]
    s_waitcnt lgkmcnt(3)
    v_mfma_f32_16x16x32_bf16 v[120:123], v[28:31], v[68:71], v[120:123]
    s_waitcnt lgkmcnt(2)
    v_mfma_f32_16x16x32_bf16 v[120:123], v[32:35], v[72:75], v[120:123]
    s_waitcnt lgkmcnt(1)
    v_mfma_f32_16x16x32_bf16 v[120:123], v[36:39], v[76:79], v[120:123]
    s_waitcnt lgkmcnt(0)
    v_mfma_f32_16x16x32_bf16 v[120:123], v[40:43], v[80:83], v[120:123]
    s_mov_b64 exec, s[14:15]
    s_nop 4
    s_cmp_eq_u32 s6, 0
    s_cbranch_scc1 Lrem_46
    v_and_or_b32 v12, v120, s97, v118
    v_and_or_b32 v13, v121, s97, v118
    v_and_or_b32 v14, v122, s97, v118
    v_and_or_b32 v15, v123, s97, v118
    buffer_store_dwordx4 v[12:15], v7, s[60:63], s76 offen
Lst_47:
    s_mov_b64 exec, 1
    ds_add_u32 v116, v117 offset:26796
    s_mov_b64 exec, -1
    s_branch L_fin
L_M23:
    s_cmp_ge_u32 s5, 4
    s_cbranch_scc1 L_M2
    v_mov_b32 v116, 0
    v_mov_b32 v117, 1
    v_mov_b32 v118, s27
    s_add_u32 s9, s5, 14
    s_lshr_b32 s8, s9, 1
    s_and_b32 s9, s9, 1
    s_lshl_b32 s11, s8, 7
    s_mul_i32 s73, s4, 1152
    s_add_u32 s11, s11, s73
    s_mul_i32 s73, s9, 2654208
    s_add_u32 s11, s11, s73
    s_and_b32 s10, s3, 3
    s_mul_i32 s12, s10, 9
Lgo_48:
Lspin_50:
    ds_read_b32 v119, v116 offset:26768
    s_waitcnt lgkmcnt(0)
    v_readfirstlane_b32 s101, v119
    s_cmp_ge_u32 s101, 4
    s_cbranch_scc1 Lspind_51
    s_sleep 2
    s_branch Lspin_50
Lspind_51:
Lgo2_49:
    s_mul_i32 s75, s12, 73728
    s_add_u32 s73, s11, s75
    v_lshrrev_b32 v5, 3, v0
    v_mul_u32_u24 v5, 9216, v5
    v_lshl_add_u32 v5, v126, 4, v5
    s_lshl_b32 s75, s12, 10
    s_add_u32 m0, s75, 122880
    s_nop 0
    buffer_load_dwordx4 v5, s[48:51], s73 offen nt lds
    s_add_u32 m0, m0, 1024
    s_add_u32 s73, s73, 73728
    s_nop 0
    buffer_load_dwordx4 v5, s[48:51], s73 offen nt lds
    s_add_u32 m0, m0, 1024
    s_add_u32 s73, s73, 73728
    s_nop 0
    buffer_load_dwordx4 v5, s[48:51], s73 offen nt lds
    s_add_u32 m0, m0, 1024
    s_add_u32 s73, s73, 73728
    s_nop 0
    buffer_load_dwordx4 v5, s[48:51], s73 offen nt lds
    s_add_u32 m0, m0, 1024
    s_add_u32 s73, s73, 73728
    s_nop 0
    buffer_load_dwordx4 v5, s[48:51], s73 offen nt lds
    s_add_u32 m0, m0, 1024
    s_add_u32 s73, s73, 73728
    s_nop 0
    buffer_load_dwordx4 v5, s[48:51], s73 offen nt lds
    s_add_u32 m0, m0, 1024
    s_add_u32 s73, s73, 73728
    s_nop 0
    buffer_load_dwordx4 v5, s[48:51], s73 offen nt lds
    s_add_u32 m0, m0, 1024
    s_add_u32 s73, s73, 73728
    s_nop 0
    buffer_load_dwordx4 v5, s[48:51], s73 offen nt lds
    s_add_u32 m0, m0, 1024
    s_add_u32 s73, s73, 73728
    s_nop 0
    buffer_load_dwordx4 v5, s[48:51], s73 offen nt lds
    s_lshl_b32 s75, s10, 5
    s_add_u32 s75, s75, 122880
    v_lshl_add_u32 v5, v124, 7, v125
    v_add_u32 v5, s75, v5
    v_mul_u32_u24 v6, 1168, v126
    v_lshl_add_u32 v6, v2, 4, v6
    s_lshl_b32 s76, s4, 1
    s_add_u32 s76, s76, s9
    s_mul_i32 s76, s76, 18432
    s_mul_i32 s73, s9, 576
    v_add_u32 v6, s73, v6
    v_mul_u32_u24 v7, 2304, v1
    v_lshl_add_u32 v7, v2, 4, v7
    s_lshl_b32 s75, s8, 8
    s_add_u32 s76, s76, s75
    s_lshl_b32 s75, s10, 6
    s_add_u32 s76, s76, s75
    s_add_u32 s76, s76, 1114112
    s_waitcnt vmcnt(0)
    s_mov_b64 exec, 1
    ds_add_u32 v116, v117 offset:26784
    s_mov_b64 exec, -1
Lspin_52:
    ds_read_b32 v119, v116 offset:26784
    s_waitcnt lgkmcnt(0)
    v_readfirstlane_b32 s101, v119
    s_cmp_ge_u32 s101, 4
    s_cbranch_scc1 Lspind_53
    s_sleep 1
    s_branch Lspin_52
Lspind_53:
    ds_read_b64_tr_b16 v[8:9], v5 offset:0
    ds_read_b64_tr_b16 v[10:11], v5 offset:512
    ds_read_b64_tr_b16 v[12:13], v5 offset:4096
    ds_read_b64_tr_b16 v[14:15], v5 offset:4608
    ds_read_b64_tr_b16 v[16:17], v5 offset:8192
    ds_read_b64_tr_b16 v[18:19], v5 offset:8704
    ds_read_b64_tr_b16 v[20:21], v5 offset:12288
    ds_read_b64_tr_b16 v[22:23], v5 offset:12800
    ds_read_b64_tr_b16 v[24:25], v5 offset:16384
    ds_read_b64_tr_b16 v[26:27], v5 offset:16896
    s_waitcnt lgkmcnt(0)
    ds_read_b64_tr_b16 v[28:29], v5 offset:20480
    ds_read_b64_tr_b16 v[30:31], v5 offset:20992
    ds_read_b64_tr_b16 v[32:33], v5 offset:24576
    ds_read_b64_tr_b16 v[34:35], v5 offset:25088
    ds_read_b64_tr_b16 v[36:37], v5 offset:28672
    ds_read_b64_tr_b16 v[38:39], v5 offset:29184
    ds_read_b64_tr_b16 v[40:41], v5 offset:32768
    ds_read_b64_tr_b16 v[42:43], v5 offset:33280
Lspin_54:
    ds_read_b32 v119, v116 offset:26764
    s_waitcnt lgkmcnt(0)
    v_readfirstlane_b32 s101, v119
    s_cmp_ge_u32 s101, 1
    s_cbranch_scc1 Lspind_55
    s_sleep 2
    s_branch Lspin_54
Lspind_55:
Lspin_56:
    ds_read_b32 v119, v116 offset:26764
    s_waitcnt lgkmcnt(0)
    v_readfirstlane_b32 s101, v119
    s_cmp_ge_u32 s101, 8
    s_cbranch_scc0 Lspin_56
    ds_read_b128 v[48:51], v6 offset:0
    ds_read_b128 v[52:55], v6 offset:64
    ds_read_b128 v[56:59], v6 offset:128
    ds_read_b128 v[60:63], v6 offset:192
    ds_read_b128 v[64:67], v6 offset:256
    ds_read_b128 v[68:71], v6 offset:320
    ds_read_b128 v[72:75], v6 offset:384
    ds_read_b128 v[76:79], v6 offset:448
    ds_read_b128 v[80:83], v6 offset:512
    s_waitcnt lgkmcnt(8)
    v_mfma_f32_16x16x32_bf16 v[120:123], v[8:11], v[48:51], 0
    s_waitcnt lgkmcnt(7)
    v_mfma_f32_16x16x32_bf16 v[120:123], v[12:15], v[52:55], v[120:123]
    s_waitcnt lgkmcnt(6)
    v_mfma_f32_16x16x32_bf16 v[120:123], v[16:19], v[56:59], v[120:123]
    s_waitcnt lgkmcnt(5)
    v_mfma_f32_16x16x32_bf16 v[120:123], v[20:23], v[60:63], v[120:123]
    s_waitcnt lgkmcnt(4)
    v_mfma_f32_16x16x32_bf16 v[120:123], v[24:27], v[64:67], v[120:123]
    s_waitcnt lgkmcnt(3)
    v_mfma_f32_16x16x32_bf16 v[120:123], v[28:31], v[68:71], v[120:123]
    s_waitcnt lgkmcnt(2)
    v_mfma_f32_16x16x32_bf16 v[120:123], v[32:35], v[72:75], v[120:123]
    s_waitcnt lgkmcnt(1)
    v_mfma_f32_16x16x32_bf16 v[120:123], v[36:39], v[76:79], v[120:123]
    s_waitcnt lgkmcnt(0)
    v_mfma_f32_16x16x32_bf16 v[120:123], v[40:43], v[80:83], v[120:123]
    s_mov_b64 exec, s[14:15]
    s_nop 4
    s_cmp_eq_u32 s6, 0
    s_cbranch_scc1 Lrem_58
    v_and_or_b32 v12, v120, s97, v118
    v_and_or_b32 v13, v121, s97, v118
    v_and_or_b32 v14, v122, s97, v118
    v_and_or_b32 v15, v123, s97, v118
    buffer_store_dwordx4 v[12:15], v7, s[60:63], s76 offen
Lst_59:
    s_mov_b64 exec, 1
    ds_add_u32 v116, v117 offset:26796
    s_mov_b64 exec, -1
    s_branch L_fin
L_M2:
    v_mov_b32 v116, 0
    v_mov_b32 v117, 1
    v_mov_b32 v118, s27
    s_sub_u32 s9, s5, 4
    s_lshr_b32 s8, s9, 1
    s_and_b32 s9, s9, 1
    s_lshl_b32 s11, s8, 7
    s_mul_i32 s73, s4, 663552
    s_add_u32 s11, s11, s73
    s_mul_i32 s73, s9, 331776
    s_add_u32 s11, s11, s73
    s_and_b32 s10, s3, 3
    s_mul_i32 s12, s10, 9
    s_cmp_lt_u32 s5, 14
    s_cbranch_scc1 Lgo_60
Lspin_62:
    ds_read_b32 v119, v116 offset:26788
    s_waitcnt lgkmcnt(0)
    v_readfirstlane_b32 s101, v119
    s_cmp_ge_u32 s101, 8
    s_cbranch_scc1 Lspind_63
    s_sleep 2
    s_branch Lspin_62
Lspind_63:
    s_branch Lgo2_61
Lgo_60:
Lspin_64:
    ds_read_b32 v119, v116 offset:26768
    s_waitcnt lgkmcnt(0)
    v_readfirstlane_b32 s101, v119
    s_cmp_ge_u32 s101, 4
    s_cbranch_scc1 Lspind_65
    s_sleep 2
    s_branch Lspin_64
Lspind_65:
Lgo2_61:
    s_mul_i32 s75, s12, 9216
    s_add_u32 s73, s11, s75
    v_lshrrev_b32 v5, 3, v0
    v_mul_u32_u24 v5, 1152, v5
    v_lshl_add_u32 v5, v126, 4, v5
    s_lshl_b32 s75, s12, 10
    s_add_u32 m0, s75, 122880
    s_nop 0
    buffer_load_dwordx4 v5, s[52:55], s73 offen nt lds
    s_add_u32 m0, m0, 1024
    s_add_u32 s73, s73, 9216
    s_nop 0
    buffer_load_dwordx4 v5, s[52:55], s73 offen nt lds
    s_add_u32 m0, m0, 1024
    s_add_u32 s73, s73, 9216
    s_nop 0
    buffer_load_dwordx4 v5, s[52:55], s73 offen nt lds
    s_add_u32 m0, m0, 1024
    s_add_u32 s73, s73, 9216
    s_nop 0
    buffer_load_dwordx4 v5, s[52:55], s73 offen nt lds
    s_add_u32 m0, m0, 1024
    s_add_u32 s73, s73, 9216
    s_nop 0
    buffer_load_dwordx4 v5, s[52:55], s73 offen nt lds
    s_add_u32 m0, m0, 1024
    s_add_u32 s73, s73, 9216
    s_nop 0
    buffer_load_dwordx4 v5, s[52:55], s73 offen nt lds
    s_add_u32 m0, m0, 1024
    s_add_u32 s73, s73, 9216
    s_nop 0
    buffer_load_dwordx4 v5, s[52:55], s73 offen nt lds
    s_add_u32 m0, m0, 1024
    s_add_u32 s73, s73, 9216
    s_nop 0
    buffer_load_dwordx4 v5, s[52:55], s73 offen nt lds
    s_add_u32 m0, m0, 1024
    s_add_u32 s73, s73, 9216
    s_nop 0
    buffer_load_dwordx4 v5, s[52:55], s73 offen nt lds
    s_lshl_b32 s75, s10, 5
    s_add_u32 s75, s75, 122880
    v_lshl_add_u32 v5, v124, 7, v125
    v_add_u32 v5, s75, v5
    v_mul_u32_u24 v6, 1168, v126
    v_lshl_add_u32 v6, v2, 4, v6
    s_lshl_b32 s76, s4, 1
    s_add_u32 s76, s76, s9
    s_mul_i32 s76, s76, 18432
    v_lshlrev_b32 v7, 6, v1
    v_lshl_add_u32 v7, v2, 4, v7
    s_lshl_b32 s75, s8, 11
    s_add_u32 s76, s76, s75
    s_lshl_b32 s75, s10, 9
    s_add_u32 s76, s76, s75
    s_add_u32 s76, s76, 819200
    s_waitcnt vmcnt(0)
    s_mov_b64 exec, 1
    ds_add_u32 v116, v117 offset:26784
    s_mov_b64 exec, -1
Lspin_66:
    ds_read_b32 v119, v116 offset:26784
    s_waitcnt lgkmcnt(0)
    v_readfirstlane_b32 s101, v119
    s_cmp_ge_u32 s101, 4
    s_cbranch_scc1 Lspind_67
    s_sleep 1
    s_branch Lspin_66
Lspind_67:
    ds_read_b64_tr_b16 v[8:9], v5 offset:0
    ds_read_b64_tr_b16 v[10:11], v5 offset:512
    ds_read_b64_tr_b16 v[12:13], v5 offset:4096
    ds_read_b64_tr_b16 v[14:15], v5 offset:4608
    ds_read_b64_tr_b16 v[16:17], v5 offset:8192
    ds_read_b64_tr_b16 v[18:19], v5 offset:8704
    ds_read_b64_tr_b16 v[20:21], v5 offset:12288
    ds_read_b64_tr_b16 v[22:23], v5 offset:12800
    ds_read_b64_tr_b16 v[24:25], v5 offset:16384
    ds_read_b64_tr_b16 v[26:27], v5 offset:16896
    s_waitcnt lgkmcnt(0)
    ds_read_b64_tr_b16 v[28:29], v5 offset:20480
    ds_read_b64_tr_b16 v[30:31], v5 offset:20992
    ds_read_b64_tr_b16 v[32:33], v5 offset:24576
    ds_read_b64_tr_b16 v[34:35], v5 offset:25088
    ds_read_b64_tr_b16 v[36:37], v5 offset:28672
    ds_read_b64_tr_b16 v[38:39], v5 offset:29184
    ds_read_b64_tr_b16 v[40:41], v5 offset:32768
    ds_read_b64_tr_b16 v[42:43], v5 offset:33280
Lspin_68:
    ds_read_b32 v119, v116 offset:26780
    s_waitcnt lgkmcnt(0)
    v_readfirstlane_b32 s101, v119
    s_cmp_ge_u32 s101, 1
    s_cbranch_scc1 Lspind_69
    s_sleep 2
    s_branch Lspin_68
Lspind_69:
Lspin_70:
    ds_read_b32 v119, v116 offset:26780
    s_waitcnt lgkmcnt(0)
    v_readfirstlane_b32 s101, v119
    s_cmp_ge_u32 s101, 8
    s_cbranch_scc0 Lspin_70
    ds_read_b128 v[48:51], v6 offset:33792
    ds_read_b128 v[52:55], v6 offset:33856
    ds_read_b128 v[56:59], v6 offset:33920
    ds_read_b128 v[60:63], v6 offset:33984
    ds_read_b128 v[64:67], v6 offset:34048
    ds_read_b128 v[68:71], v6 offset:34112
    ds_read_b128 v[72:75], v6 offset:34176
    ds_read_b128 v[76:79], v6 offset:34240
    ds_read_b128 v[80:83], v6 offset:34304
    s_waitcnt lgkmcnt(8)
    v_mfma_f32_16x16x32_bf16 v[120:123], v[8:11], v[48:51], 0
    s_waitcnt lgkmcnt(7)
    v_mfma_f32_16x16x32_bf16 v[120:123], v[12:15], v[52:55], v[120:123]
    s_waitcnt lgkmcnt(6)
    v_mfma_f32_16x16x32_bf16 v[120:123], v[16:19], v[56:59], v[120:123]
    s_waitcnt lgkmcnt(5)
    v_mfma_f32_16x16x32_bf16 v[120:123], v[20:23], v[60:63], v[120:123]
    s_waitcnt lgkmcnt(4)
    v_mfma_f32_16x16x32_bf16 v[120:123], v[24:27], v[64:67], v[120:123]
    s_waitcnt lgkmcnt(3)
    v_mfma_f32_16x16x32_bf16 v[120:123], v[28:31], v[68:71], v[120:123]
    s_waitcnt lgkmcnt(2)
    v_mfma_f32_16x16x32_bf16 v[120:123], v[32:35], v[72:75], v[120:123]
    s_waitcnt lgkmcnt(1)
    v_mfma_f32_16x16x32_bf16 v[120:123], v[36:39], v[76:79], v[120:123]
    s_waitcnt lgkmcnt(0)
    v_mfma_f32_16x16x32_bf16 v[120:123], v[40:43], v[80:83], v[120:123]
    s_mov_b64 exec, s[14:15]
    s_nop 6
    v_and_or_b32 v12, v120, s97, v118
    v_and_or_b32 v13, v121, s97, v118
    v_and_or_b32 v14, v122, s97, v118
    v_and_or_b32 v15, v123, s97, v118
    buffer_store_dwordx4 v[12:15], v7, s[60:63], s76 offen sc1
    s_mov_b64 exec, -1
L_fin:
L_end:
    s_endpgm
Lrem_10:
    buffer_store_dwordx4 v[28:31], v32, s[60:63], s99 offen sc1
    s_branch Lst_11
Lrem_12:
    buffer_store_dword v8, v117, s[60:63], s76 offen sc1
    s_branch Lst_13
Lrem_28:
    buffer_store_dword v25, v30, s[60:63], s78 offen sc1
    s_branch Lst_29
Lrem_46:
    v_and_or_b32 v12, v120, s97, v118
    v_and_or_b32 v13, v121, s97, v118
    v_and_or_b32 v14, v122, s97, v118
    v_and_or_b32 v15, v123, s97, v118
    buffer_store_dwordx4 v[12:15], v7, s[60:63], s76 offen sc1
    s_branch Lst_47
Lrem_58:
    v_and_or_b32 v12, v120, s97, v118
    v_and_or_b32 v13, v121, s97, v118
    v_and_or_b32 v14, v122, s97, v118
    v_and_or_b32 v15, v123, s97, v118
    buffer_store_dwordx4 v[12:15], v7, s[60:63], s76 offen sc1
    s_branch Lst_59
L_codeend:
.section .rodata,"a"
.p2align 6
.amdhsa_kernel sequential_preLN__sliding_block_cached__dense_activation_relu__decode_kernel
  .amdhsa_next_free_vgpr 128
  .amdhsa_next_free_sgpr 102
  .amdhsa_accum_offset 128
  .amdhsa_group_segment_fixed_size 0
  .amdhsa_kernarg_size 88
  .amdhsa_user_sgpr_count 2
  .amdhsa_user_sgpr_kernarg_segment_ptr 1
  .amdhsa_system_sgpr_workgroup_id_x 1
  .amdhsa_float_denorm_mode_32 3
.end_amdhsa_kernel
```
